```python
import torch

def _softmax(x, axis=-1):
    return torch.softmax(x, dim=axis)
def _gelu(x):
    return torch.nn.functional.gelu(x, approximate="tanh")
def _silu(x):
    return torch.nn.functional.silu(x)
def _sigmoid(x):
    return torch.sigmoid(x)
def _layernorm(x, axis=-1, eps=1e-5):
    m = x.mean(dim=axis, keepdim=True)
    v = x.var(dim=axis, keepdim=True, unbiased=False)
    return (x - m) / torch.sqrt(v + eps)
def _scatter_add(tgt, idx, src, axis=0):
    return tgt.clone().index_add_(axis, idx, src)
def _segment_sum(src, seg, n):
    out = torch.zeros((n,) + src.shape[1:], dtype=src.dtype)
    return out.index_add_(0, seg, src)
def _pad(x, pw):
    flat = tuple(v for pair in reversed(pw) for v in pair)
    return torch.nn.functional.pad(x, flat)

kernel_name = 'gated_mix__ssm_conv_s4d__glu_gated_reglu__prompt'

def setup_inputs():

    _w = (lambda a: (lambda t: t.to(torch.bfloat16) if t.is_floating_point() else t)(torch.as_tensor(a)))
    def _A_setup():
        Bsz, L, D, N = 1, 2048, 512, 128
        return {
            "u": _w((lambda *s: torch.randn(*s, dtype=torch.bfloat16) * 0.05)(Bsz, L, D)),
            "log_A_real": _w((lambda *s: torch.randn(*s, dtype=torch.bfloat16) * 3.2)(D, N) * 0.5),
            "A_imag": _w((lambda *s: torch.randn(*s, dtype=torch.bfloat16) * 0.05)(D, N) * 3.14),
            "C_real": _w((lambda *s: torch.randn(*s, dtype=torch.bfloat16) * 0.05)(D, N) / N ** 0.5),
            "C_imag": _w((lambda *s: torch.randn(*s, dtype=torch.bfloat16) * 0.1)(D, N) / N ** 0.5),
            "log_dt": _w((lambda *s: torch.randn(*s, dtype=torch.bfloat16) * 0.05)(D) * 0.5 - 4.0),
            "D_skip": _w((lambda *s: torch.randn(*s, dtype=torch.bfloat16) * 0.05)(D)),
        }
    _A_in = _A_setup()

    def _B_setup():
        B, S, D, F = 1, 2048, 512, 1792
        return {
            "x": _w((lambda *s: torch.randn(*s, dtype=torch.bfloat16) * 0.05)(B, S, D)),
            "W_gate": _w((lambda *s: torch.randn(*s, dtype=torch.bfloat16) * 0.8)(D, F) * (2.0 / D) ** 0.5),
            "W_up": _w((lambda *s: torch.randn(*s, dtype=torch.bfloat16) * 0.8)(D, F) * (2.0 / D) ** 0.5),
            "W_down": _w((lambda *s: torch.randn(*s, dtype=torch.bfloat16) * 0.8)(F, D) * (1.0 / F) ** 0.5),
        }
    _B_in = _B_setup()

    return {
        "A_u": _A_in["u"],
        "A_log_A_real": _A_in["log_A_real"],
        "A_A_imag": _A_in["A_imag"],
        "A_C_real": _A_in["C_real"],
        "A_C_imag": _A_in["C_imag"],
        "A_log_dt": _A_in["log_dt"],
        "A_D_skip": _A_in["D_skip"],
        "B_x": _B_in["x"],
        "B_W_gate": _B_in["W_gate"],
        "B_W_up": _B_in["W_up"],
        "B_W_down": _B_in["W_down"],
        "gate_w": _w((lambda *s: torch.randn(*s, dtype=torch.bfloat16) * 0.05)(512) * 16.0),
    }

def reference(A_u, A_log_A_real, A_A_imag, A_C_real, A_C_imag, A_log_dt, A_D_skip, B_x, B_W_gate, B_W_up, B_W_down, gate_w):
    def _A_ref(u, log_A_real, A_imag, C_real, C_imag, log_dt, D_skip):
        L = u.shape[1]
        dt = torch.exp(log_dt)
        A = -torch.exp(log_A_real) + 1j * A_imag
        C = (C_real + 1j * C_imag) * dt[:, None]
        pos = (lambda x, dt: x.to(dt))(torch.arange(L), log_dt.dtype)
        P = torch.exp((A * dt[:, None])[:, :, None] * pos[None, None, :])
        K = 2.0 * torch.einsum("dn,dnl->dl", C, P).real
        L2 = 2 * L
        u_t = (lambda x, *d: x.permute(*d))(u, 0, 2, 1)
        Kf = (lambda x, *a, **k: torch.fft.rfft(x.float(), *a, **k))(K, L2)
        Uf = (lambda x, *a, **k: torch.fft.rfft(x.float(), *a, **k))(u_t, L2)
        y = (lambda x, *a, **k: torch.fft.irfft(x, *a, **k).to(torch.bfloat16))(Uf * Kf[None, :, :], L2)[:, :, :L]
        y = (lambda x, *d: x.permute(*d))(y, 0, 2, 1)
        return y + u * D_skip[None, None, :]

    def _B_ref(x, W_gate, W_up, W_down):
        gate = torch.einsum("bsd,df->bsf", x, W_gate)
        up = torch.einsum("bsd,df->bsf", x, W_up)
        gate = gate * (lambda x, dt: x.to(dt))(gate > 0, gate.dtype)
        h = gate * up
        return torch.einsum("bsf,fd->bsd", h, W_down)

    x = A_u
    g = _sigmoid((x * gate_w).sum(-1, keepdims=True))
    a = _A_ref(x, A_log_A_real, A_A_imag, A_C_real, A_C_imag, A_log_dt, A_D_skip)
    b = _B_ref(x, B_W_gate, B_W_up, B_W_down)
    return g * a + (1 - g) * b
```

```asm
; @launch grid=(256,1,1) block=(512,1,1) lds=163840
.amdgcn_target "amdgcn-amd-amdhsa--gfx950"
.text
.globl gated_mix__ssm_conv_s4d__glu_gated_reglu__prompt_kernel
.p2align 8
.type gated_mix__ssm_conv_s4d__glu_gated_reglu__prompt_kernel,@function
gated_mix__ssm_conv_s4d__glu_gated_reglu__prompt_kernel:
  s_cmp_ge_u32 s2, 256
  s_cbranch_scc1 Lend
  s_load_dwordx16 s[4:19], s[0:1], 0
  s_load_dwordx8 s[20:27], s[0:1], 64
  s_load_dwordx4 s[28:31], s[0:1], 96
  s_load_dwordx2 s[32:33], s[0:1], 112
  v_lshrrev_b32 v2, 6, v0
  v_and_b32 v1, 63, v0
  v_readfirstlane_b32 s34, v2
  s_and_b32 s35, s2, 7
  s_lshr_b32 s36, s2, 3
  s_and_b32 s37, s36, 3
  s_lshr_b32 s38, s36, 2
  s_lshl_b32 s39, s35, 2
  s_add_u32 s39, s39, s37
  s_mov_b32 s42, 2097152
  s_mov_b32 s43, 0x00020000
  s_mov_b32 s46, 1835008
  s_mov_b32 s47, 0x00020000
  s_mov_b32 s50, 1835008
  s_mov_b32 s51, 0x00020000
  s_mov_b32 s54, 1835008
  s_mov_b32 s55, 0x00020000
  s_mov_b32 s58, 11603968
  s_mov_b32 s59, 0x00020000
  s_mov_b32 s62, 2097152
  s_mov_b32 s63, 0x00020000
  s_mov_b32 s66, 256
  s_mov_b32 s67, 0x00020000
  s_lshr_b32 s72, s35, 1
  s_lshl_b32 s72, s72, 2
  s_add_u32 s72, s72, s37
  s_and_b32 s73, s35, 1
  s_mul_i32 s73, s73, 7
  s_add_u32 s73, s73, s38
  s_mov_b32 s74, s35
  s_waitcnt lgkmcnt(0)
  s_mov_b64 s[40:41], s[4:5]
  s_mov_b64 s[44:45], s[20:21]
  s_mov_b64 s[48:49], s[22:23]
  s_mov_b64 s[52:53], s[24:25]
  s_mov_b64 s[56:57], s[32:33]
  s_mov_b64 s[60:61], s[28:29]
  s_mov_b64 s[64:65], s[30:31]
  s_lshr_b32 s70, s24, 7
  s_sub_u32 s38, s38, s70
  s_add_u32 s38, s38, 4
  s_and_b32 s38, s38, 7
  s_cmp_ge_u32 s34, 4
  s_cbranch_scc1 LA
  s_cmp_ge_u32 s36, 28
  s_cbranch_scc1 LGaux
  v_lshrrev_b32 v26, 4, v1
  s_lshl_b32 s70, s34, 3
  v_add_u32 v24, s70, v26
  v_mul_u32_u24 v24, 3584, v24
  s_lshl_b32 s70, s73, 8
  v_and_b32 v25, 1, v1
  v_lshl_add_u32 v24, v25, 4, v24
  v_add_u32 v24, s70, v24
  v_bfe_u32 v25, v1, 1, 3
  v_lshlrev_b32 v27, 1, v26
  v_xor_b32 v25, v25, v27
  v_lshl_add_u32 v52, v25, 5, v24
  v_add_u32 v53, 14336, v52
  v_xor_b32 v25, 1, v25
  v_lshl_add_u32 v54, v25, 5, v24
  v_add_u32 v55, 14336, v54
  s_lshl_b32 s78, s34, 12
  s_lshl_b32 s85, s34, 11
  s_add_u32 m0, s85, 0
  s_add_u32 s86, s74, 0
  s_and_b32 s86, s86, 7
  s_mul_i32 s3, s86, 229376
  buffer_load_dwordx4 v52, s[44:47], s3 offen lds
  s_add_u32 m0, s85, 1024
  s_nop 0
  buffer_load_dwordx4 v53, s[44:47], s3 offen lds
  s_add_u32 m0, s85, 8192
  s_nop 0
  buffer_load_dwordx4 v54, s[48:51], s3 offen lds
  s_add_u32 m0, s85, 9216
  s_nop 0
  buffer_load_dwordx4 v55, s[48:51], s3 offen lds
  v_lshrrev_b32 v24, 3, v1
  v_and_b32 v25, 7, v1
  v_xor_b32 v25, v25, v26
  s_lshl_b32 s70, s72, 2
  s_add_u32 s70, s70, s34
  s_lshl_b32 s70, s70, 15
  v_lshl_add_u32 v24, v24, 10, s70
  v_lshl_add_u32 v48, v25, 4, v24
  v_xor_b32 v25, 4, v25
  v_lshl_add_u32 v49, v25, 4, v24
  v_add_u32 v49, 0x2000, v49
  v_add_u32 v50, 0x4000, v48
  v_add_u32 v51, 0x4000, v49
  s_add_u32 m0, s78, 65536
  s_add_u32 s86, s74, 0
  s_and_b32 s86, s86, 7
  s_lshl_b32 s87, s86, 7
  buffer_load_dwordx4 v48, s[40:43], s87 offen lds
  s_add_u32 m0, s78, 66560
  s_nop 0
  buffer_load_dwordx4 v49, s[40:43], s87 offen lds
  s_add_u32 m0, s78, 67584
  s_nop 0
  buffer_load_dwordx4 v50, s[40:43], s87 offen lds
  s_add_u32 m0, s78, 68608
  s_nop 0
  buffer_load_dwordx4 v51, s[40:43], s87 offen lds
  s_add_u32 m0, s85, 16384
  s_add_u32 s86, s74, 0
  s_and_b32 s86, s86, 7
  s_mul_i32 s3, s86, 229376
  s_add_u32 s3, s3, 114688
  buffer_load_dwordx4 v52, s[44:47], s3 offen lds
  s_add_u32 m0, s85, 17408
  s_nop 0
  buffer_load_dwordx4 v53, s[44:47], s3 offen lds
  s_add_u32 m0, s85, 24576
  s_nop 0
  buffer_load_dwordx4 v54, s[48:51], s3 offen lds
  s_add_u32 m0, s85, 25600
  s_nop 0
  buffer_load_dwordx4 v55, s[48:51], s3 offen lds
  v_lshlrev_b32 v15, 4, v1
  v_lshrrev_b32 v16, 5, v1
  v_bfe_u32 v17, v1, 2, 2
  v_lshl_add_u32 v16, v16, 2, v17
  v_lshlrev_b32 v16, 7, v16
  v_and_b32 v18, 3, v1
  v_lshl_add_u32 v16, v18, 3, v16
  v_bfe_u32 v18, v1, 4, 1
  v_lshl_add_u32 v16, v18, 5, v16
  v_bfe_u32 v18, v1, 3, 1
  v_lshl_add_u32 v16, v18, 6, v16
  v_add_u32 v10, s78, v16
  v_xor_b32 v11, 64, v10
  v_add_u32 v12, 0x10000, v10
  v_add_u32 v13, 0x10000, v11
  v_lshrrev_b32 v16, 3, v1
  v_and_b32 v17, 7, v1
  v_bfe_u32 v18, v1, 4, 1
  v_lshlrev_b32 v18, 2, v18
  v_xor_b32 v17, v17, v18
  v_lshlrev_b32 v17, 4, v17
  v_lshl_add_u32 v16, v16, 10, v17
  s_lshl_b32 s70, s38, 7
  v_add_u32 v14, s70, v16
  s_mul_i32 s70, s34, 458752
  s_mov_b32 s79, s37
  s_and_b32 s79, s79, 1
  s_mul_i32 s71, s79, 229376
  s_add_u32 s76, s70, s71
  s_sub_u32 s77, s70, s71
  s_add_u32 s77, s77, 229376
  s_and_b32 s70, s34, 1
  s_lshr_b32 s71, s34, 1
  v_bfe_u32 v16, v1, 4, 1
  v_bfe_u32 v17, v1, 2, 2
  v_lshl_add_u32 v18, v17, 1, v16
  s_lshl_b32 s75, s71, 2
  v_xor_b32 v18, s75, v18
  v_lshrrev_b32 v19, 5, v1
  v_lshl_add_u32 v17, v19, 3, v17
  v_lshlrev_b32 v17, 8, v17
  v_lshl_add_u32 v17, v16, 13, v17
  v_and_b32 v16, 3, v1
  v_lshl_add_u32 v17, v16, 3, v17
  v_xor_b32 v16, 0, v18
  v_lshl_add_u32 v2, v16, 5, v17
  v_xor_b32 v16, 1, v18
  v_lshl_add_u32 v3, v16, 5, v17
  v_xor_b32 v16, 2, v18
  v_lshl_add_u32 v4, v16, 5, v17
  v_xor_b32 v16, 3, v18
  v_lshl_add_u32 v5, v16, 5, v17
  v_and_b32 v16, 31, v1
  v_bfe_u32 v17, v1, 1, 3
  v_xor_b32 v17, v19, v17
  s_lshl_b32 s75, s70, 13
  s_add_u32 s75, s75, 65536
  v_lshl_add_u32 v16, v16, 7, s75
  v_xor_b32 v18, 0, v17
  v_lshl_add_u32 v6, v18, 4, v16
  v_xor_b32 v18, 2, v17
  v_lshl_add_u32 v7, v18, 4, v16
  v_xor_b32 v18, 4, v17
  v_lshl_add_u32 v8, v18, 4, v16
  v_xor_b32 v18, 6, v17
  v_lshl_add_u32 v9, v18, 4, v16
  s_lshl_b32 s82, s72, 1
  s_add_u32 s82, s82, s70
  s_lshl_b32 s84, s82, 2
  s_mul_i32 s82, s82, 224
  s_lshl_b32 s75, s73, 1
  s_add_u32 s75, s75, s71
  s_mul_i32 s83, s75, 37
  s_lshr_b32 s83, s83, 8
  s_add_u32 s84, s84, s83
  s_lshl_b32 s84, s84, 8
  s_lshl_b32 s75, s75, 2
  s_add_u32 s82, s82, s75
  s_lshl_b32 s82, s82, 10
  s_add_u32 s82, s82, 2097152
  s_add_u32 s83, s82, 114688
  s_add_u32 s84, s84, 11550720
  s_add_u32 m0, s85, 32768
  s_add_u32 s86, s74, 1
  s_and_b32 s86, s86, 7
  s_mul_i32 s3, s86, 229376
  buffer_load_dwordx4 v52, s[44:47], s3 offen lds
  s_add_u32 m0, s85, 33792
  s_nop 0
  buffer_load_dwordx4 v53, s[44:47], s3 offen lds
  s_add_u32 m0, s85, 40960
  s_nop 0
  buffer_load_dwordx4 v54, s[48:51], s3 offen lds
  s_add_u32 m0, s85, 41984
  s_nop 0
  buffer_load_dwordx4 v55, s[48:51], s3 offen lds
  s_add_u32 m0, s78, 81920
  s_add_u32 s86, s74, 1
  s_and_b32 s86, s86, 7
  s_lshl_b32 s87, s86, 7
  buffer_load_dwordx4 v48, s[40:43], s87 offen lds
  s_add_u32 m0, s78, 82944
  s_nop 0
  buffer_load_dwordx4 v49, s[40:43], s87 offen lds
  s_add_u32 m0, s78, 83968
  s_nop 0
  buffer_load_dwordx4 v50, s[40:43], s87 offen lds
  s_add_u32 m0, s78, 84992
  s_nop 0
  buffer_load_dwordx4 v51, s[40:43], s87 offen lds
  s_waitcnt vmcnt(12)
  s_barrier
  s_setprio 2
  ds_read_b128 v[96:99], v6 offset:0
  ds_read_b64_tr_b16 v[64:65], v2 offset:0
  ds_read_b64_tr_b16 v[66:67], v2 offset:1024
  ds_read_b128 v[100:103], v6 offset:4096
  ds_read_b64_tr_b16 v[68:69], v3 offset:0
  ds_read_b64_tr_b16 v[70:71], v3 offset:1024
  ds_read_b64_tr_b16 v[72:73], v4 offset:0
  ds_read_b64_tr_b16 v[74:75], v4 offset:1024
  ds_read_b64_tr_b16 v[76:77], v5 offset:0
  ds_read_b64_tr_b16 v[78:79], v5 offset:1024
  s_add_u32 m0, s85, 49152
  s_add_u32 s86, s74, 1
  s_and_b32 s86, s86, 7
  s_mul_i32 s3, s86, 229376
  s_add_u32 s3, s3, 114688
  s_waitcnt lgkmcnt(7)
  v_mfma_f32_32x32x16_bf16 v[128:143], v[64:67], v[96:99], 0
  ds_read_b128 v[104:107], v7 offset:0
  ds_read_b64_tr_b16 v[80:81], v2 offset:4096
  buffer_load_dwordx4 v52, s[44:47], s3 offen lds
  s_add_u32 m0, s85, 50176
  s_waitcnt lgkmcnt(8)
  v_mfma_f32_32x32x16_bf16 v[144:159], v[64:67], v[100:103], 0
  ds_read_b64_tr_b16 v[82:83], v2 offset:5120
  ds_read_b128 v[108:111], v7 offset:4096
  buffer_load_dwordx4 v53, s[44:47], s3 offen lds
  s_add_u32 m0, s85, 57344
  s_waitcnt lgkmcnt(8)
  v_mfma_f32_32x32x16_bf16 v[160:175], v[68:71], v[96:99], 0
  ds_read_b64_tr_b16 v[84:85], v3 offset:4096
  ds_read_b64_tr_b16 v[86:87], v3 offset:5120
  buffer_load_dwordx4 v54, s[48:51], s3 offen lds
  s_add_u32 m0, s85, 58368
  v_mfma_f32_32x32x16_bf16 v[176:191], v[68:71], v[100:103], 0
  ds_read_b64_tr_b16 v[88:89], v4 offset:4096
  ds_read_b64_tr_b16 v[90:91], v4 offset:5120
  buffer_load_dwordx4 v55, s[48:51], s3 offen lds
  s_add_u32 m0, s78, 98304
  s_add_u32 s86, s74, 2
  s_and_b32 s86, s86, 7
  s_lshl_b32 s87, s86, 7
  s_waitcnt lgkmcnt(10)
  v_mfma_f32_32x32x16_bf16 v[192:207], v[72:75], v[96:99], 0
  ds_read_b64_tr_b16 v[92:93], v5 offset:4096
  ds_read_b64_tr_b16 v[94:95], v5 offset:5120
  buffer_load_dwordx4 v48, s[40:43], s87 offen lds
  s_add_u32 m0, s78, 99328
  v_mfma_f32_32x32x16_bf16 v[208:223], v[72:75], v[100:103], 0
  buffer_load_dwordx4 v49, s[40:43], s87 offen lds
  s_add_u32 m0, s78, 100352
  s_waitcnt lgkmcnt(10)
  v_mfma_f32_32x32x16_bf16 v[224:239], v[76:79], v[96:99], 0
  buffer_load_dwordx4 v50, s[40:43], s87 offen lds
  s_add_u32 m0, s78, 101376
  v_mfma_f32_32x32x16_bf16 v[240:255], v[76:79], v[100:103], 0
  buffer_load_dwordx4 v51, s[40:43], s87 offen lds
  s_waitcnt vmcnt(16)
  s_waitcnt lgkmcnt(0)
  s_barrier
  v_mfma_f32_32x32x16_bf16 v[128:143], v[80:83], v[104:107], v[128:143]
  ds_read_b128 v[96:99], v8 offset:0
  ds_read_b64_tr_b16 v[64:65], v2 offset:16384
  v_mfma_f32_32x32x16_bf16 v[144:159], v[80:83], v[108:111], v[144:159]
  ds_read_b64_tr_b16 v[66:67], v2 offset:17408
  ds_read_b128 v[100:103], v8 offset:4096
  v_mfma_f32_32x32x16_bf16 v[160:175], v[84:87], v[104:107], v[160:175]
  ds_read_b64_tr_b16 v[68:69], v3 offset:16384
  ds_read_b64_tr_b16 v[70:71], v3 offset:17408
  v_mfma_f32_32x32x16_bf16 v[176:191], v[84:87], v[108:111], v[176:191]
  ds_read_b64_tr_b16 v[72:73], v4 offset:16384
  ds_read_b64_tr_b16 v[74:75], v4 offset:17408
  v_mfma_f32_32x32x16_bf16 v[192:207], v[88:91], v[104:107], v[192:207]
  ds_read_b64_tr_b16 v[76:77], v5 offset:16384
  ds_read_b64_tr_b16 v[78:79], v5 offset:17408
  s_add_u32 m0, s85, 0
  s_add_u32 s86, s74, 2
  s_and_b32 s86, s86, 7
  s_mul_i32 s3, s86, 229376
  v_mfma_f32_32x32x16_bf16 v[208:223], v[88:91], v[108:111], v[208:223]
  buffer_load_dwordx4 v52, s[44:47], s3 offen lds
  s_add_u32 m0, s85, 1024
  v_mfma_f32_32x32x16_bf16 v[224:239], v[92:95], v[104:107], v[224:239]
  buffer_load_dwordx4 v53, s[44:47], s3 offen lds
  s_add_u32 m0, s85, 8192
  v_mfma_f32_32x32x16_bf16 v[240:255], v[92:95], v[108:111], v[240:255]
  buffer_load_dwordx4 v54, s[48:51], s3 offen lds
  s_waitcnt lgkmcnt(7)
  v_mfma_f32_32x32x16_bf16 v[128:143], v[64:67], v[96:99], v[128:143]
  ds_read_b128 v[104:107], v9 offset:0
  ds_read_b64_tr_b16 v[80:81], v2 offset:20480
  s_waitcnt lgkmcnt(8)
  v_mfma_f32_32x32x16_bf16 v[144:159], v[64:67], v[100:103], v[144:159]
  ds_read_b64_tr_b16 v[82:83], v2 offset:21504
  ds_read_b128 v[108:111], v9 offset:4096
  s_waitcnt lgkmcnt(8)
  v_mfma_f32_32x32x16_bf16 v[160:175], v[68:71], v[96:99], v[160:175]
  ds_read_b64_tr_b16 v[84:85], v3 offset:20480
  ds_read_b64_tr_b16 v[86:87], v3 offset:21504
  v_mfma_f32_32x32x16_bf16 v[176:191], v[68:71], v[100:103], v[176:191]
  ds_read_b64_tr_b16 v[88:89], v4 offset:20480
  ds_read_b64_tr_b16 v[90:91], v4 offset:21504
  s_waitcnt lgkmcnt(10)
  v_mfma_f32_32x32x16_bf16 v[192:207], v[72:75], v[96:99], v[192:207]
  ds_read_b64_tr_b16 v[92:93], v5 offset:20480
  ds_read_b64_tr_b16 v[94:95], v5 offset:21504
  v_mfma_f32_32x32x16_bf16 v[208:223], v[72:75], v[100:103], v[208:223]
  s_waitcnt lgkmcnt(10)
  v_mfma_f32_32x32x16_bf16 v[224:239], v[76:79], v[96:99], v[224:239]
  s_add_u32 m0, s85, 9216
  v_mfma_f32_32x32x16_bf16 v[240:255], v[76:79], v[100:103], v[240:255]
  buffer_load_dwordx4 v55, s[48:51], s3 offen lds
  s_waitcnt vmcnt(12)
  s_waitcnt lgkmcnt(0)
  s_barrier
  v_mfma_f32_32x32x16_bf16 v[128:143], v[80:83], v[104:107], v[128:143]
  ds_read_b128 v[96:99], v6 offset:16384
  ds_read_b64_tr_b16 v[64:65], v2 offset:32768
  v_mfma_f32_32x32x16_bf16 v[144:159], v[80:83], v[108:111], v[144:159]
  ds_read_b64_tr_b16 v[66:67], v2 offset:33792
  ds_read_b128 v[100:103], v6 offset:20480
  v_mfma_f32_32x32x16_bf16 v[160:175], v[84:87], v[104:107], v[160:175]
  ds_read_b64_tr_b16 v[68:69], v3 offset:32768
  ds_read_b64_tr_b16 v[70:71], v3 offset:33792
  v_mfma_f32_32x32x16_bf16 v[176:191], v[84:87], v[108:111], v[176:191]
  ds_read_b64_tr_b16 v[72:73], v4 offset:32768
  ds_read_b64_tr_b16 v[74:75], v4 offset:33792
  v_mfma_f32_32x32x16_bf16 v[192:207], v[88:91], v[104:107], v[192:207]
  ds_read_b64_tr_b16 v[76:77], v5 offset:32768
  ds_read_b64_tr_b16 v[78:79], v5 offset:33792
  s_add_u32 m0, s85, 16384
  s_add_u32 s86, s74, 2
  s_and_b32 s86, s86, 7
  s_mul_i32 s3, s86, 229376
  s_add_u32 s3, s3, 114688
  v_mfma_f32_32x32x16_bf16 v[208:223], v[88:91], v[108:111], v[208:223]
  buffer_load_dwordx4 v52, s[44:47], s3 offen lds
  s_add_u32 m0, s85, 17408
  v_mfma_f32_32x32x16_bf16 v[224:239], v[92:95], v[104:107], v[224:239]
  buffer_load_dwordx4 v53, s[44:47], s3 offen lds
  s_add_u32 m0, s85, 24576
  v_mfma_f32_32x32x16_bf16 v[240:255], v[92:95], v[108:111], v[240:255]
  buffer_load_dwordx4 v54, s[48:51], s3 offen lds
  s_waitcnt lgkmcnt(7)
  v_mfma_f32_32x32x16_bf16 v[128:143], v[64:67], v[96:99], v[128:143]
  ds_read_b128 v[104:107], v7 offset:16384
  ds_read_b64_tr_b16 v[80:81], v2 offset:36864
  s_waitcnt lgkmcnt(8)
  v_mfma_f32_32x32x16_bf16 v[144:159], v[64:67], v[100:103], v[144:159]
  ds_read_b64_tr_b16 v[82:83], v2 offset:37888
  ds_read_b128 v[108:111], v7 offset:20480
  s_waitcnt lgkmcnt(8)
  v_mfma_f32_32x32x16_bf16 v[160:175], v[68:71], v[96:99], v[160:175]
  ds_read_b64_tr_b16 v[84:85], v3 offset:36864
  ds_read_b64_tr_b16 v[86:87], v3 offset:37888
  v_mfma_f32_32x32x16_bf16 v[176:191], v[68:71], v[100:103], v[176:191]
  ds_read_b64_tr_b16 v[88:89], v4 offset:36864
  ds_read_b64_tr_b16 v[90:91], v4 offset:37888
  s_waitcnt lgkmcnt(10)
  v_mfma_f32_32x32x16_bf16 v[192:207], v[72:75], v[96:99], v[192:207]
  ds_read_b64_tr_b16 v[92:93], v5 offset:36864
  ds_read_b64_tr_b16 v[94:95], v5 offset:37888
  s_add_u32 m0, s85, 25600
  v_mfma_f32_32x32x16_bf16 v[208:223], v[72:75], v[100:103], v[208:223]
  buffer_load_dwordx4 v55, s[48:51], s3 offen lds
  s_add_u32 m0, s78, 65536
  s_add_u32 s86, s74, 3
  s_and_b32 s86, s86, 7
  s_lshl_b32 s87, s86, 7
  s_waitcnt lgkmcnt(10)
  v_mfma_f32_32x32x16_bf16 v[224:239], v[76:79], v[96:99], v[224:239]
  buffer_load_dwordx4 v48, s[40:43], s87 offen lds
  s_add_u32 m0, s78, 66560
  v_mfma_f32_32x32x16_bf16 v[240:255], v[76:79], v[100:103], v[240:255]
  buffer_load_dwordx4 v49, s[40:43], s87 offen lds
  s_waitcnt vmcnt(14)
  s_waitcnt lgkmcnt(0)
  s_barrier
  v_mfma_f32_32x32x16_bf16 v[128:143], v[80:83], v[104:107], v[128:143]
  ds_read_b128 v[96:99], v8 offset:16384
  ds_read_b64_tr_b16 v[64:65], v2 offset:49152
  v_mfma_f32_32x32x16_bf16 v[144:159], v[80:83], v[108:111], v[144:159]
  ds_read_b64_tr_b16 v[66:67], v2 offset:50176
  ds_read_b128 v[100:103], v8 offset:20480
  v_mfma_f32_32x32x16_bf16 v[160:175], v[84:87], v[104:107], v[160:175]
  ds_read_b64_tr_b16 v[68:69], v3 offset:49152
  ds_read_b64_tr_b16 v[70:71], v3 offset:50176
  v_mfma_f32_32x32x16_bf16 v[176:191], v[84:87], v[108:111], v[176:191]
  ds_read_b64_tr_b16 v[72:73], v4 offset:49152
  ds_read_b64_tr_b16 v[74:75], v4 offset:50176
  v_mfma_f32_32x32x16_bf16 v[192:207], v[88:91], v[104:107], v[192:207]
  ds_read_b64_tr_b16 v[76:77], v5 offset:49152
  ds_read_b64_tr_b16 v[78:79], v5 offset:50176
  s_add_u32 m0, s85, 32768
  s_add_u32 s86, s74, 3
  s_and_b32 s86, s86, 7
  s_mul_i32 s3, s86, 229376
  v_mfma_f32_32x32x16_bf16 v[208:223], v[88:91], v[108:111], v[208:223]
  buffer_load_dwordx4 v52, s[44:47], s3 offen lds
  s_add_u32 m0, s85, 33792
  v_mfma_f32_32x32x16_bf16 v[224:239], v[92:95], v[104:107], v[224:239]
  buffer_load_dwordx4 v53, s[44:47], s3 offen lds
  s_add_u32 m0, s85, 40960
  v_mfma_f32_32x32x16_bf16 v[240:255], v[92:95], v[108:111], v[240:255]
  buffer_load_dwordx4 v54, s[48:51], s3 offen lds
  s_waitcnt lgkmcnt(7)
  v_mfma_f32_32x32x16_bf16 v[128:143], v[64:67], v[96:99], v[128:143]
  ds_read_b128 v[104:107], v9 offset:16384
  ds_read_b64_tr_b16 v[80:81], v2 offset:53248
  s_waitcnt lgkmcnt(8)
  v_mfma_f32_32x32x16_bf16 v[144:159], v[64:67], v[100:103], v[144:159]
  ds_read_b64_tr_b16 v[82:83], v2 offset:54272
  ds_read_b128 v[108:111], v9 offset:20480
  s_waitcnt lgkmcnt(8)
  v_mfma_f32_32x32x16_bf16 v[160:175], v[68:71], v[96:99], v[160:175]
  ds_read_b64_tr_b16 v[84:85], v3 offset:53248
  ds_read_b64_tr_b16 v[86:87], v3 offset:54272
  v_mfma_f32_32x32x16_bf16 v[176:191], v[68:71], v[100:103], v[176:191]
  ds_read_b64_tr_b16 v[88:89], v4 offset:53248
  ds_read_b64_tr_b16 v[90:91], v4 offset:54272
  s_waitcnt lgkmcnt(10)
  v_mfma_f32_32x32x16_bf16 v[192:207], v[72:75], v[96:99], v[192:207]
  ds_read_b64_tr_b16 v[92:93], v5 offset:53248
  ds_read_b64_tr_b16 v[94:95], v5 offset:54272
  s_add_u32 m0, s85, 41984
  v_mfma_f32_32x32x16_bf16 v[208:223], v[72:75], v[100:103], v[208:223]
  buffer_load_dwordx4 v55, s[48:51], s3 offen lds
  s_add_u32 m0, s78, 67584
  s_add_u32 s86, s74, 3
  s_and_b32 s86, s86, 7
  s_lshl_b32 s87, s86, 7
  s_waitcnt lgkmcnt(10)
  v_mfma_f32_32x32x16_bf16 v[224:239], v[76:79], v[96:99], v[224:239]
  buffer_load_dwordx4 v50, s[40:43], s87 offen lds
  s_add_u32 m0, s78, 68608
  v_mfma_f32_32x32x16_bf16 v[240:255], v[76:79], v[100:103], v[240:255]
  buffer_load_dwordx4 v51, s[40:43], s87 offen lds
  s_waitcnt vmcnt(12)
  s_waitcnt lgkmcnt(0)
  s_barrier
  v_mfma_f32_32x32x16_bf16 v[128:143], v[80:83], v[104:107], v[128:143]
  ds_read_b128 v[96:99], v6 offset:32768
  ds_read_b64_tr_b16 v[64:65], v2 offset:0
  v_mfma_f32_32x32x16_bf16 v[144:159], v[80:83], v[108:111], v[144:159]
  ds_read_b64_tr_b16 v[66:67], v2 offset:1024
  ds_read_b128 v[100:103], v6 offset:36864
  v_mfma_f32_32x32x16_bf16 v[160:175], v[84:87], v[104:107], v[160:175]
  ds_read_b64_tr_b16 v[68:69], v3 offset:0
  ds_read_b64_tr_b16 v[70:71], v3 offset:1024
  v_mfma_f32_32x32x16_bf16 v[176:191], v[84:87], v[108:111], v[176:191]
  ds_read_b64_tr_b16 v[72:73], v4 offset:0
  ds_read_b64_tr_b16 v[74:75], v4 offset:1024
  v_mfma_f32_32x32x16_bf16 v[192:207], v[88:91], v[104:107], v[192:207]
  ds_read_b64_tr_b16 v[76:77], v5 offset:0
  ds_read_b64_tr_b16 v[78:79], v5 offset:1024
  s_add_u32 m0, s85, 49152
  s_add_u32 s86, s74, 3
  s_and_b32 s86, s86, 7
  s_mul_i32 s3, s86, 229376
  s_add_u32 s3, s3, 114688
  v_mfma_f32_32x32x16_bf16 v[208:223], v[88:91], v[108:111], v[208:223]
  buffer_load_dwordx4 v52, s[44:47], s3 offen lds
  s_add_u32 m0, s85, 50176
  v_mfma_f32_32x32x16_bf16 v[224:239], v[92:95], v[104:107], v[224:239]
  buffer_load_dwordx4 v53, s[44:47], s3 offen lds
  s_add_u32 m0, s85, 57344
  v_mfma_f32_32x32x16_bf16 v[240:255], v[92:95], v[108:111], v[240:255]
  buffer_load_dwordx4 v54, s[48:51], s3 offen lds
  s_waitcnt lgkmcnt(7)
  v_mfma_f32_32x32x16_bf16 v[128:143], v[64:67], v[96:99], v[128:143]
  ds_read_b128 v[104:107], v7 offset:32768
  ds_read_b64_tr_b16 v[80:81], v2 offset:4096
  s_waitcnt lgkmcnt(8)
  v_mfma_f32_32x32x16_bf16 v[144:159], v[64:67], v[100:103], v[144:159]
  ds_read_b64_tr_b16 v[82:83], v2 offset:5120
  ds_read_b128 v[108:111], v7 offset:36864
  s_waitcnt lgkmcnt(8)
  v_mfma_f32_32x32x16_bf16 v[160:175], v[68:71], v[96:99], v[160:175]
  ds_read_b64_tr_b16 v[84:85], v3 offset:4096
  ds_read_b64_tr_b16 v[86:87], v3 offset:5120
  v_mfma_f32_32x32x16_bf16 v[176:191], v[68:71], v[100:103], v[176:191]
  ds_read_b64_tr_b16 v[88:89], v4 offset:4096
  ds_read_b64_tr_b16 v[90:91], v4 offset:5120
  s_waitcnt lgkmcnt(10)
  v_mfma_f32_32x32x16_bf16 v[192:207], v[72:75], v[96:99], v[192:207]
  ds_read_b64_tr_b16 v[92:93], v5 offset:4096
  ds_read_b64_tr_b16 v[94:95], v5 offset:5120
  s_add_u32 m0, s85, 58368
  v_mfma_f32_32x32x16_bf16 v[208:223], v[72:75], v[100:103], v[208:223]
  buffer_load_dwordx4 v55, s[48:51], s3 offen lds
  s_add_u32 m0, s78, 81920
  s_add_u32 s86, s74, 4
  s_and_b32 s86, s86, 7
  s_lshl_b32 s87, s86, 7
  s_waitcnt lgkmcnt(10)
  v_mfma_f32_32x32x16_bf16 v[224:239], v[76:79], v[96:99], v[224:239]
  buffer_load_dwordx4 v48, s[40:43], s87 offen lds
  s_add_u32 m0, s78, 82944
  v_mfma_f32_32x32x16_bf16 v[240:255], v[76:79], v[100:103], v[240:255]
  buffer_load_dwordx4 v49, s[40:43], s87 offen lds
  s_waitcnt vmcnt(14)
  s_waitcnt lgkmcnt(0)
  s_barrier
  v_mfma_f32_32x32x16_bf16 v[128:143], v[80:83], v[104:107], v[128:143]
  ds_read_b128 v[96:99], v8 offset:32768
  ds_read_b64_tr_b16 v[64:65], v2 offset:16384
  v_mfma_f32_32x32x16_bf16 v[144:159], v[80:83], v[108:111], v[144:159]
  ds_read_b64_tr_b16 v[66:67], v2 offset:17408
  ds_read_b128 v[100:103], v8 offset:36864
  v_mfma_f32_32x32x16_bf16 v[160:175], v[84:87], v[104:107], v[160:175]
  ds_read_b64_tr_b16 v[68:69], v3 offset:16384
  ds_read_b64_tr_b16 v[70:71], v3 offset:17408
  v_mfma_f32_32x32x16_bf16 v[176:191], v[84:87], v[108:111], v[176:191]
  ds_read_b64_tr_b16 v[72:73], v4 offset:16384
  ds_read_b64_tr_b16 v[74:75], v4 offset:17408
  v_mfma_f32_32x32x16_bf16 v[192:207], v[88:91], v[104:107], v[192:207]
  ds_read_b64_tr_b16 v[76:77], v5 offset:16384
  ds_read_b64_tr_b16 v[78:79], v5 offset:17408
  s_add_u32 m0, s85, 0
  s_add_u32 s86, s74, 4
  s_and_b32 s86, s86, 7
  s_mul_i32 s3, s86, 229376
  v_mfma_f32_32x32x16_bf16 v[208:223], v[88:91], v[108:111], v[208:223]
  buffer_load_dwordx4 v52, s[44:47], s3 offen lds
  s_add_u32 m0, s85, 1024
  v_mfma_f32_32x32x16_bf16 v[224:239], v[92:95], v[104:107], v[224:239]
  buffer_load_dwordx4 v53, s[44:47], s3 offen lds
  s_add_u32 m0, s85, 8192
  v_mfma_f32_32x32x16_bf16 v[240:255], v[92:95], v[108:111], v[240:255]
  buffer_load_dwordx4 v54, s[48:51], s3 offen lds
  s_waitcnt lgkmcnt(7)
  v_mfma_f32_32x32x16_bf16 v[128:143], v[64:67], v[96:99], v[128:143]
  ds_read_b128 v[104:107], v9 offset:32768
  ds_read_b64_tr_b16 v[80:81], v2 offset:20480
  s_waitcnt lgkmcnt(8)
  v_mfma_f32_32x32x16_bf16 v[144:159], v[64:67], v[100:103], v[144:159]
  ds_read_b64_tr_b16 v[82:83], v2 offset:21504
  ds_read_b128 v[108:111], v9 offset:36864
  s_waitcnt lgkmcnt(8)
  v_mfma_f32_32x32x16_bf16 v[160:175], v[68:71], v[96:99], v[160:175]
  ds_read_b64_tr_b16 v[84:85], v3 offset:20480
  ds_read_b64_tr_b16 v[86:87], v3 offset:21504
  v_mfma_f32_32x32x16_bf16 v[176:191], v[68:71], v[100:103], v[176:191]
  ds_read_b64_tr_b16 v[88:89], v4 offset:20480
  ds_read_b64_tr_b16 v[90:91], v4 offset:21504
  s_waitcnt lgkmcnt(10)
  v_mfma_f32_32x32x16_bf16 v[192:207], v[72:75], v[96:99], v[192:207]
  ds_read_b64_tr_b16 v[92:93], v5 offset:20480
  ds_read_b64_tr_b16 v[94:95], v5 offset:21504
  s_add_u32 m0, s85, 9216
  v_mfma_f32_32x32x16_bf16 v[208:223], v[72:75], v[100:103], v[208:223]
  buffer_load_dwordx4 v55, s[48:51], s3 offen lds
  s_add_u32 m0, s78, 83968
  s_add_u32 s86, s74, 4
  s_and_b32 s86, s86, 7
  s_lshl_b32 s87, s86, 7
  s_waitcnt lgkmcnt(10)
  v_mfma_f32_32x32x16_bf16 v[224:239], v[76:79], v[96:99], v[224:239]
  buffer_load_dwordx4 v50, s[40:43], s87 offen lds
  s_add_u32 m0, s78, 84992
  v_mfma_f32_32x32x16_bf16 v[240:255], v[76:79], v[100:103], v[240:255]
  buffer_load_dwordx4 v51, s[40:43], s87 offen lds
  s_waitcnt vmcnt(12)
  s_waitcnt lgkmcnt(0)
  s_barrier
  v_mfma_f32_32x32x16_bf16 v[128:143], v[80:83], v[104:107], v[128:143]
  ds_read_b128 v[96:99], v6 offset:0
  ds_read_b64_tr_b16 v[64:65], v2 offset:32768
  v_mfma_f32_32x32x16_bf16 v[144:159], v[80:83], v[108:111], v[144:159]
  ds_read_b64_tr_b16 v[66:67], v2 offset:33792
  ds_read_b128 v[100:103], v6 offset:4096
  v_mfma_f32_32x32x16_bf16 v[160:175], v[84:87], v[104:107], v[160:175]
  ds_read_b64_tr_b16 v[68:69], v3 offset:32768
  ds_read_b64_tr_b16 v[70:71], v3 offset:33792
  v_mfma_f32_32x32x16_bf16 v[176:191], v[84:87], v[108:111], v[176:191]
  ds_read_b64_tr_b16 v[72:73], v4 offset:32768
  ds_read_b64_tr_b16 v[74:75], v4 offset:33792
  v_mfma_f32_32x32x16_bf16 v[192:207], v[88:91], v[104:107], v[192:207]
  ds_read_b64_tr_b16 v[76:77], v5 offset:32768
  ds_read_b64_tr_b16 v[78:79], v5 offset:33792
  s_add_u32 m0, s85, 16384
  s_add_u32 s86, s74, 4
  s_and_b32 s86, s86, 7
  s_mul_i32 s3, s86, 229376
  s_add_u32 s3, s3, 114688
  v_mfma_f32_32x32x16_bf16 v[208:223], v[88:91], v[108:111], v[208:223]
  buffer_load_dwordx4 v52, s[44:47], s3 offen lds
  s_add_u32 m0, s85, 17408
  v_mfma_f32_32x32x16_bf16 v[224:239], v[92:95], v[104:107], v[224:239]
  buffer_load_dwordx4 v53, s[44:47], s3 offen lds
  s_add_u32 m0, s85, 24576
  v_mfma_f32_32x32x16_bf16 v[240:255], v[92:95], v[108:111], v[240:255]
  buffer_load_dwordx4 v54, s[48:51], s3 offen lds
  s_waitcnt lgkmcnt(7)
  v_mfma_f32_32x32x16_bf16 v[128:143], v[64:67], v[96:99], v[128:143]
  ds_read_b128 v[104:107], v7 offset:0
  ds_read_b64_tr_b16 v[80:81], v2 offset:36864
  s_waitcnt lgkmcnt(8)
  v_mfma_f32_32x32x16_bf16 v[144:159], v[64:67], v[100:103], v[144:159]
  ds_read_b64_tr_b16 v[82:83], v2 offset:37888
  ds_read_b128 v[108:111], v7 offset:4096
  s_waitcnt lgkmcnt(8)
  v_mfma_f32_32x32x16_bf16 v[160:175], v[68:71], v[96:99], v[160:175]
  ds_read_b64_tr_b16 v[84:85], v3 offset:36864
  ds_read_b64_tr_b16 v[86:87], v3 offset:37888
  v_mfma_f32_32x32x16_bf16 v[176:191], v[68:71], v[100:103], v[176:191]
  ds_read_b64_tr_b16 v[88:89], v4 offset:36864
  ds_read_b64_tr_b16 v[90:91], v4 offset:37888
  s_waitcnt lgkmcnt(10)
  v_mfma_f32_32x32x16_bf16 v[192:207], v[72:75], v[96:99], v[192:207]
  ds_read_b64_tr_b16 v[92:93], v5 offset:36864
  ds_read_b64_tr_b16 v[94:95], v5 offset:37888
  s_add_u32 m0, s85, 25600
  v_mfma_f32_32x32x16_bf16 v[208:223], v[72:75], v[100:103], v[208:223]
  buffer_load_dwordx4 v55, s[48:51], s3 offen lds
  s_add_u32 m0, s78, 98304
  s_add_u32 s86, s74, 5
  s_and_b32 s86, s86, 7
  s_lshl_b32 s87, s86, 7
  s_waitcnt lgkmcnt(10)
  v_mfma_f32_32x32x16_bf16 v[224:239], v[76:79], v[96:99], v[224:239]
  buffer_load_dwordx4 v48, s[40:43], s87 offen lds
  s_add_u32 m0, s78, 99328
  v_mfma_f32_32x32x16_bf16 v[240:255], v[76:79], v[100:103], v[240:255]
  buffer_load_dwordx4 v49, s[40:43], s87 offen lds
  s_waitcnt vmcnt(14)
  s_waitcnt lgkmcnt(0)
  s_barrier
  v_mfma_f32_32x32x16_bf16 v[128:143], v[80:83], v[104:107], v[128:143]
  ds_read_b128 v[96:99], v8 offset:0
  ds_read_b64_tr_b16 v[64:65], v2 offset:49152
  v_mfma_f32_32x32x16_bf16 v[144:159], v[80:83], v[108:111], v[144:159]
  ds_read_b64_tr_b16 v[66:67], v2 offset:50176
  ds_read_b128 v[100:103], v8 offset:4096
  v_mfma_f32_32x32x16_bf16 v[160:175], v[84:87], v[104:107], v[160:175]
  ds_read_b64_tr_b16 v[68:69], v3 offset:49152
  ds_read_b64_tr_b16 v[70:71], v3 offset:50176
  v_mfma_f32_32x32x16_bf16 v[176:191], v[84:87], v[108:111], v[176:191]
  ds_read_b64_tr_b16 v[72:73], v4 offset:49152
  ds_read_b64_tr_b16 v[74:75], v4 offset:50176
  v_mfma_f32_32x32x16_bf16 v[192:207], v[88:91], v[104:107], v[192:207]
  ds_read_b64_tr_b16 v[76:77], v5 offset:49152
  ds_read_b64_tr_b16 v[78:79], v5 offset:50176
  s_add_u32 m0, s85, 32768
  s_add_u32 s86, s74, 5
  s_and_b32 s86, s86, 7
  s_mul_i32 s3, s86, 229376
  v_mfma_f32_32x32x16_bf16 v[208:223], v[88:91], v[108:111], v[208:223]
  buffer_load_dwordx4 v52, s[44:47], s3 offen lds
  s_add_u32 m0, s85, 33792
  v_mfma_f32_32x32x16_bf16 v[224:239], v[92:95], v[104:107], v[224:239]
  buffer_load_dwordx4 v53, s[44:47], s3 offen lds
  s_add_u32 m0, s85, 40960
  v_mfma_f32_32x32x16_bf16 v[240:255], v[92:95], v[108:111], v[240:255]
  buffer_load_dwordx4 v54, s[48:51], s3 offen lds
  s_waitcnt lgkmcnt(7)
  v_mfma_f32_32x32x16_bf16 v[128:143], v[64:67], v[96:99], v[128:143]
  ds_read_b128 v[104:107], v9 offset:0
  ds_read_b64_tr_b16 v[80:81], v2 offset:53248
  s_waitcnt lgkmcnt(8)
  v_mfma_f32_32x32x16_bf16 v[144:159], v[64:67], v[100:103], v[144:159]
  ds_read_b64_tr_b16 v[82:83], v2 offset:54272
  ds_read_b128 v[108:111], v9 offset:4096
  s_waitcnt lgkmcnt(8)
  v_mfma_f32_32x32x16_bf16 v[160:175], v[68:71], v[96:99], v[160:175]
  ds_read_b64_tr_b16 v[84:85], v3 offset:53248
  ds_read_b64_tr_b16 v[86:87], v3 offset:54272
  v_mfma_f32_32x32x16_bf16 v[176:191], v[68:71], v[100:103], v[176:191]
  ds_read_b64_tr_b16 v[88:89], v4 offset:53248
  ds_read_b64_tr_b16 v[90:91], v4 offset:54272
  s_waitcnt lgkmcnt(10)
  v_mfma_f32_32x32x16_bf16 v[192:207], v[72:75], v[96:99], v[192:207]
  ds_read_b64_tr_b16 v[92:93], v5 offset:53248
  ds_read_b64_tr_b16 v[94:95], v5 offset:54272
  s_add_u32 m0, s85, 41984
  v_mfma_f32_32x32x16_bf16 v[208:223], v[72:75], v[100:103], v[208:223]
  buffer_load_dwordx4 v55, s[48:51], s3 offen lds
  s_add_u32 m0, s78, 100352
  s_add_u32 s86, s74, 5
  s_and_b32 s86, s86, 7
  s_lshl_b32 s87, s86, 7
  s_waitcnt lgkmcnt(10)
  v_mfma_f32_32x32x16_bf16 v[224:239], v[76:79], v[96:99], v[224:239]
  buffer_load_dwordx4 v50, s[40:43], s87 offen lds
  s_add_u32 m0, s78, 101376
  v_mfma_f32_32x32x16_bf16 v[240:255], v[76:79], v[100:103], v[240:255]
  buffer_load_dwordx4 v51, s[40:43], s87 offen lds
  s_waitcnt vmcnt(12)
  s_waitcnt lgkmcnt(0)
  s_barrier
  v_mfma_f32_32x32x16_bf16 v[128:143], v[80:83], v[104:107], v[128:143]
  ds_read_b128 v[96:99], v6 offset:16384
  ds_read_b64_tr_b16 v[64:65], v2 offset:0
  v_mfma_f32_32x32x16_bf16 v[144:159], v[80:83], v[108:111], v[144:159]
  ds_read_b64_tr_b16 v[66:67], v2 offset:1024
  ds_read_b128 v[100:103], v6 offset:20480
  v_mfma_f32_32x32x16_bf16 v[160:175], v[84:87], v[104:107], v[160:175]
  ds_read_b64_tr_b16 v[68:69], v3 offset:0
  ds_read_b64_tr_b16 v[70:71], v3 offset:1024
  v_mfma_f32_32x32x16_bf16 v[176:191], v[84:87], v[108:111], v[176:191]
  ds_read_b64_tr_b16 v[72:73], v4 offset:0
  ds_read_b64_tr_b16 v[74:75], v4 offset:1024
  v_mfma_f32_32x32x16_bf16 v[192:207], v[88:91], v[104:107], v[192:207]
  ds_read_b64_tr_b16 v[76:77], v5 offset:0
  ds_read_b64_tr_b16 v[78:79], v5 offset:1024
  s_add_u32 m0, s85, 49152
  s_add_u32 s86, s74, 5
  s_and_b32 s86, s86, 7
  s_mul_i32 s3, s86, 229376
  s_add_u32 s3, s3, 114688
  v_mfma_f32_32x32x16_bf16 v[208:223], v[88:91], v[108:111], v[208:223]
  buffer_load_dwordx4 v52, s[44:47], s3 offen lds
  s_add_u32 m0, s85, 50176
  v_mfma_f32_32x32x16_bf16 v[224:239], v[92:95], v[104:107], v[224:239]
  buffer_load_dwordx4 v53, s[44:47], s3 offen lds
  s_add_u32 m0, s85, 57344
  v_mfma_f32_32x32x16_bf16 v[240:255], v[92:95], v[108:111], v[240:255]
  buffer_load_dwordx4 v54, s[48:51], s3 offen lds
  s_waitcnt lgkmcnt(7)
  v_mfma_f32_32x32x16_bf16 v[128:143], v[64:67], v[96:99], v[128:143]
  ds_read_b128 v[104:107], v7 offset:16384
  ds_read_b64_tr_b16 v[80:81], v2 offset:4096
  s_waitcnt lgkmcnt(8)
  v_mfma_f32_32x32x16_bf16 v[144:159], v[64:67], v[100:103], v[144:159]
  ds_read_b64_tr_b16 v[82:83], v2 offset:5120
  ds_read_b128 v[108:111], v7 offset:20480
  s_waitcnt lgkmcnt(8)
  v_mfma_f32_32x32x16_bf16 v[160:175], v[68:71], v[96:99], v[160:175]
  ds_read_b64_tr_b16 v[84:85], v3 offset:4096
  ds_read_b64_tr_b16 v[86:87], v3 offset:5120
  v_mfma_f32_32x32x16_bf16 v[176:191], v[68:71], v[100:103], v[176:191]
  ds_read_b64_tr_b16 v[88:89], v4 offset:4096
  ds_read_b64_tr_b16 v[90:91], v4 offset:5120
  s_waitcnt lgkmcnt(10)
  v_mfma_f32_32x32x16_bf16 v[192:207], v[72:75], v[96:99], v[192:207]
  ds_read_b64_tr_b16 v[92:93], v5 offset:4096
  ds_read_b64_tr_b16 v[94:95], v5 offset:5120
  s_add_u32 m0, s85, 58368
  v_mfma_f32_32x32x16_bf16 v[208:223], v[72:75], v[100:103], v[208:223]
  buffer_load_dwordx4 v55, s[48:51], s3 offen lds
  s_add_u32 m0, s78, 65536
  s_add_u32 s86, s74, 6
  s_and_b32 s86, s86, 7
  s_lshl_b32 s87, s86, 7
  s_waitcnt lgkmcnt(10)
  v_mfma_f32_32x32x16_bf16 v[224:239], v[76:79], v[96:99], v[224:239]
  buffer_load_dwordx4 v48, s[40:43], s87 offen lds
  s_add_u32 m0, s78, 66560
  v_mfma_f32_32x32x16_bf16 v[240:255], v[76:79], v[100:103], v[240:255]
  buffer_load_dwordx4 v49, s[40:43], s87 offen lds
  s_waitcnt vmcnt(14)
  s_waitcnt lgkmcnt(0)
  s_barrier
  v_mfma_f32_32x32x16_bf16 v[128:143], v[80:83], v[104:107], v[128:143]
  ds_read_b128 v[96:99], v8 offset:16384
  ds_read_b64_tr_b16 v[64:65], v2 offset:16384
  v_mfma_f32_32x32x16_bf16 v[144:159], v[80:83], v[108:111], v[144:159]
  ds_read_b64_tr_b16 v[66:67], v2 offset:17408
  ds_read_b128 v[100:103], v8 offset:20480
  v_mfma_f32_32x32x16_bf16 v[160:175], v[84:87], v[104:107], v[160:175]
  ds_read_b64_tr_b16 v[68:69], v3 offset:16384
  ds_read_b64_tr_b16 v[70:71], v3 offset:17408
  v_mfma_f32_32x32x16_bf16 v[176:191], v[84:87], v[108:111], v[176:191]
  ds_read_b64_tr_b16 v[72:73], v4 offset:16384
  ds_read_b64_tr_b16 v[74:75], v4 offset:17408
  v_mfma_f32_32x32x16_bf16 v[192:207], v[88:91], v[104:107], v[192:207]
  ds_read_b64_tr_b16 v[76:77], v5 offset:16384
  ds_read_b64_tr_b16 v[78:79], v5 offset:17408
  s_add_u32 m0, s85, 0
  s_add_u32 s86, s74, 6
  s_and_b32 s86, s86, 7
  s_mul_i32 s3, s86, 229376
  v_mfma_f32_32x32x16_bf16 v[208:223], v[88:91], v[108:111], v[208:223]
  buffer_load_dwordx4 v52, s[44:47], s3 offen lds
  s_add_u32 m0, s85, 1024
  v_mfma_f32_32x32x16_bf16 v[224:239], v[92:95], v[104:107], v[224:239]
  buffer_load_dwordx4 v53, s[44:47], s3 offen lds
  s_add_u32 m0, s85, 8192
  v_mfma_f32_32x32x16_bf16 v[240:255], v[92:95], v[108:111], v[240:255]
  buffer_load_dwordx4 v54, s[48:51], s3 offen lds
  s_waitcnt lgkmcnt(7)
  v_mfma_f32_32x32x16_bf16 v[128:143], v[64:67], v[96:99], v[128:143]
  ds_read_b128 v[104:107], v9 offset:16384
  ds_read_b64_tr_b16 v[80:81], v2 offset:20480
  s_waitcnt lgkmcnt(8)
  v_mfma_f32_32x32x16_bf16 v[144:159], v[64:67], v[100:103], v[144:159]
  ds_read_b64_tr_b16 v[82:83], v2 offset:21504
  ds_read_b128 v[108:111], v9 offset:20480
  s_waitcnt lgkmcnt(8)
  v_mfma_f32_32x32x16_bf16 v[160:175], v[68:71], v[96:99], v[160:175]
  ds_read_b64_tr_b16 v[84:85], v3 offset:20480
  ds_read_b64_tr_b16 v[86:87], v3 offset:21504
  v_mfma_f32_32x32x16_bf16 v[176:191], v[68:71], v[100:103], v[176:191]
  ds_read_b64_tr_b16 v[88:89], v4 offset:20480
  ds_read_b64_tr_b16 v[90:91], v4 offset:21504
  s_waitcnt lgkmcnt(10)
  v_mfma_f32_32x32x16_bf16 v[192:207], v[72:75], v[96:99], v[192:207]
  ds_read_b64_tr_b16 v[92:93], v5 offset:20480
  ds_read_b64_tr_b16 v[94:95], v5 offset:21504
  s_add_u32 m0, s85, 9216
  v_mfma_f32_32x32x16_bf16 v[208:223], v[72:75], v[100:103], v[208:223]
  buffer_load_dwordx4 v55, s[48:51], s3 offen lds
  s_add_u32 m0, s78, 67584
  s_add_u32 s86, s74, 6
  s_and_b32 s86, s86, 7
  s_lshl_b32 s87, s86, 7
  s_waitcnt lgkmcnt(10)
  v_mfma_f32_32x32x16_bf16 v[224:239], v[76:79], v[96:99], v[224:239]
  buffer_load_dwordx4 v50, s[40:43], s87 offen lds
  s_add_u32 m0, s78, 68608
  v_mfma_f32_32x32x16_bf16 v[240:255], v[76:79], v[100:103], v[240:255]
  buffer_load_dwordx4 v51, s[40:43], s87 offen lds
  s_waitcnt vmcnt(12)
  s_waitcnt lgkmcnt(0)
  s_barrier
  v_mfma_f32_32x32x16_bf16 v[128:143], v[80:83], v[104:107], v[128:143]
  ds_read_b128 v[96:99], v6 offset:32768
  ds_read_b64_tr_b16 v[64:65], v2 offset:32768
  v_mfma_f32_32x32x16_bf16 v[144:159], v[80:83], v[108:111], v[144:159]
  ds_read_b64_tr_b16 v[66:67], v2 offset:33792
  ds_read_b128 v[100:103], v6 offset:36864
  v_mfma_f32_32x32x16_bf16 v[160:175], v[84:87], v[104:107], v[160:175]
  ds_read_b64_tr_b16 v[68:69], v3 offset:32768
  ds_read_b64_tr_b16 v[70:71], v3 offset:33792
  v_mfma_f32_32x32x16_bf16 v[176:191], v[84:87], v[108:111], v[176:191]
  ds_read_b64_tr_b16 v[72:73], v4 offset:32768
  ds_read_b64_tr_b16 v[74:75], v4 offset:33792
  v_mfma_f32_32x32x16_bf16 v[192:207], v[88:91], v[104:107], v[192:207]
  ds_read_b64_tr_b16 v[76:77], v5 offset:32768
  ds_read_b64_tr_b16 v[78:79], v5 offset:33792
  s_add_u32 m0, s85, 16384
  s_add_u32 s86, s74, 6
  s_and_b32 s86, s86, 7
  s_mul_i32 s3, s86, 229376
  s_add_u32 s3, s3, 114688
  v_mfma_f32_32x32x16_bf16 v[208:223], v[88:91], v[108:111], v[208:223]
  buffer_load_dwordx4 v52, s[44:47], s3 offen lds
  s_add_u32 m0, s85, 17408
  v_mfma_f32_32x32x16_bf16 v[224:239], v[92:95], v[104:107], v[224:239]
  buffer_load_dwordx4 v53, s[44:47], s3 offen lds
  s_add_u32 m0, s85, 24576
  v_mfma_f32_32x32x16_bf16 v[240:255], v[92:95], v[108:111], v[240:255]
  buffer_load_dwordx4 v54, s[48:51], s3 offen lds
  s_waitcnt lgkmcnt(7)
  v_mfma_f32_32x32x16_bf16 v[128:143], v[64:67], v[96:99], v[128:143]
  ds_read_b128 v[104:107], v7 offset:32768
  ds_read_b64_tr_b16 v[80:81], v2 offset:36864
  s_waitcnt lgkmcnt(8)
  v_mfma_f32_32x32x16_bf16 v[144:159], v[64:67], v[100:103], v[144:159]
  ds_read_b64_tr_b16 v[82:83], v2 offset:37888
  ds_read_b128 v[108:111], v7 offset:36864
  s_waitcnt lgkmcnt(8)
  v_mfma_f32_32x32x16_bf16 v[160:175], v[68:71], v[96:99], v[160:175]
  ds_read_b64_tr_b16 v[84:85], v3 offset:36864
  ds_read_b64_tr_b16 v[86:87], v3 offset:37888
  v_mfma_f32_32x32x16_bf16 v[176:191], v[68:71], v[100:103], v[176:191]
  ds_read_b64_tr_b16 v[88:89], v4 offset:36864
  ds_read_b64_tr_b16 v[90:91], v4 offset:37888
  s_waitcnt lgkmcnt(10)
  v_mfma_f32_32x32x16_bf16 v[192:207], v[72:75], v[96:99], v[192:207]
  ds_read_b64_tr_b16 v[92:93], v5 offset:36864
  ds_read_b64_tr_b16 v[94:95], v5 offset:37888
  s_add_u32 m0, s85, 25600
  v_mfma_f32_32x32x16_bf16 v[208:223], v[72:75], v[100:103], v[208:223]
  buffer_load_dwordx4 v55, s[48:51], s3 offen lds
  s_add_u32 m0, s78, 81920
  s_add_u32 s86, s74, 7
  s_and_b32 s86, s86, 7
  s_lshl_b32 s87, s86, 7
  s_waitcnt lgkmcnt(10)
  v_mfma_f32_32x32x16_bf16 v[224:239], v[76:79], v[96:99], v[224:239]
  buffer_load_dwordx4 v48, s[40:43], s87 offen lds
  s_add_u32 m0, s78, 82944
  v_mfma_f32_32x32x16_bf16 v[240:255], v[76:79], v[100:103], v[240:255]
  buffer_load_dwordx4 v49, s[40:43], s87 offen lds
  s_waitcnt vmcnt(14)
  s_waitcnt lgkmcnt(0)
  s_barrier
  v_mfma_f32_32x32x16_bf16 v[128:143], v[80:83], v[104:107], v[128:143]
  ds_read_b128 v[96:99], v8 offset:32768
  ds_read_b64_tr_b16 v[64:65], v2 offset:49152
  v_mfma_f32_32x32x16_bf16 v[144:159], v[80:83], v[108:111], v[144:159]
  ds_read_b64_tr_b16 v[66:67], v2 offset:50176
  ds_read_b128 v[100:103], v8 offset:36864
  v_mfma_f32_32x32x16_bf16 v[160:175], v[84:87], v[104:107], v[160:175]
  ds_read_b64_tr_b16 v[68:69], v3 offset:49152
  ds_read_b64_tr_b16 v[70:71], v3 offset:50176
  v_mfma_f32_32x32x16_bf16 v[176:191], v[84:87], v[108:111], v[176:191]
  ds_read_b64_tr_b16 v[72:73], v4 offset:49152
  ds_read_b64_tr_b16 v[74:75], v4 offset:50176
  v_mfma_f32_32x32x16_bf16 v[192:207], v[88:91], v[104:107], v[192:207]
  ds_read_b64_tr_b16 v[76:77], v5 offset:49152
  ds_read_b64_tr_b16 v[78:79], v5 offset:50176
  s_add_u32 m0, s85, 32768
  s_add_u32 s86, s74, 7
  s_and_b32 s86, s86, 7
  s_mul_i32 s3, s86, 229376
  v_mfma_f32_32x32x16_bf16 v[208:223], v[88:91], v[108:111], v[208:223]
  buffer_load_dwordx4 v52, s[44:47], s3 offen lds
  s_add_u32 m0, s85, 33792
  v_mfma_f32_32x32x16_bf16 v[224:239], v[92:95], v[104:107], v[224:239]
  buffer_load_dwordx4 v53, s[44:47], s3 offen lds
  s_add_u32 m0, s85, 40960
  v_mfma_f32_32x32x16_bf16 v[240:255], v[92:95], v[108:111], v[240:255]
  buffer_load_dwordx4 v54, s[48:51], s3 offen lds
  s_waitcnt lgkmcnt(7)
  v_mfma_f32_32x32x16_bf16 v[128:143], v[64:67], v[96:99], v[128:143]
  ds_read_b128 v[104:107], v9 offset:32768
  ds_read_b64_tr_b16 v[80:81], v2 offset:53248
  s_waitcnt lgkmcnt(8)
  v_mfma_f32_32x32x16_bf16 v[144:159], v[64:67], v[100:103], v[144:159]
  ds_read_b64_tr_b16 v[82:83], v2 offset:54272
  ds_read_b128 v[108:111], v9 offset:36864
  s_waitcnt lgkmcnt(8)
  v_mfma_f32_32x32x16_bf16 v[160:175], v[68:71], v[96:99], v[160:175]
  ds_read_b64_tr_b16 v[84:85], v3 offset:53248
  ds_read_b64_tr_b16 v[86:87], v3 offset:54272
  v_mfma_f32_32x32x16_bf16 v[176:191], v[68:71], v[100:103], v[176:191]
  ds_read_b64_tr_b16 v[88:89], v4 offset:53248
  ds_read_b64_tr_b16 v[90:91], v4 offset:54272
  s_waitcnt lgkmcnt(10)
  v_mfma_f32_32x32x16_bf16 v[192:207], v[72:75], v[96:99], v[192:207]
  ds_read_b64_tr_b16 v[92:93], v5 offset:53248
  ds_read_b64_tr_b16 v[94:95], v5 offset:54272
  s_add_u32 m0, s85, 41984
  v_mfma_f32_32x32x16_bf16 v[208:223], v[72:75], v[100:103], v[208:223]
  buffer_load_dwordx4 v55, s[48:51], s3 offen lds
  s_add_u32 m0, s78, 83968
  s_add_u32 s86, s74, 7
  s_and_b32 s86, s86, 7
  s_lshl_b32 s87, s86, 7
  s_waitcnt lgkmcnt(10)
  v_mfma_f32_32x32x16_bf16 v[224:239], v[76:79], v[96:99], v[224:239]
  buffer_load_dwordx4 v50, s[40:43], s87 offen lds
  s_add_u32 m0, s78, 84992
  v_mfma_f32_32x32x16_bf16 v[240:255], v[76:79], v[100:103], v[240:255]
  buffer_load_dwordx4 v51, s[40:43], s87 offen lds
  s_waitcnt vmcnt(12)
  s_waitcnt lgkmcnt(0)
  s_barrier
  v_mfma_f32_32x32x16_bf16 v[128:143], v[80:83], v[104:107], v[128:143]
  ds_read_b128 v[96:99], v6 offset:0
  ds_read_b64_tr_b16 v[64:65], v2 offset:0
  v_mfma_f32_32x32x16_bf16 v[144:159], v[80:83], v[108:111], v[144:159]
  ds_read_b64_tr_b16 v[66:67], v2 offset:1024
  ds_read_b128 v[100:103], v6 offset:4096
  v_mfma_f32_32x32x16_bf16 v[160:175], v[84:87], v[104:107], v[160:175]
  ds_read_b64_tr_b16 v[68:69], v3 offset:0
  ds_read_b64_tr_b16 v[70:71], v3 offset:1024
  v_mfma_f32_32x32x16_bf16 v[176:191], v[84:87], v[108:111], v[176:191]
  ds_read_b64_tr_b16 v[72:73], v4 offset:0
  ds_read_b64_tr_b16 v[74:75], v4 offset:1024
  s_add_u32 m0, s85, 49152
  s_add_u32 s86, s74, 7
  s_and_b32 s86, s86, 7
  s_mul_i32 s3, s86, 229376
  s_add_u32 s3, s3, 114688
  v_mfma_f32_32x32x16_bf16 v[192:207], v[88:91], v[104:107], v[192:207]
  ds_read_b64_tr_b16 v[76:77], v5 offset:0
  ds_read_b64_tr_b16 v[78:79], v5 offset:1024
  buffer_load_dwordx4 v52, s[44:47], s3 offen lds
  s_add_u32 m0, s85, 50176
  v_mfma_f32_32x32x16_bf16 v[208:223], v[88:91], v[108:111], v[208:223]
  buffer_load_dwordx4 v53, s[44:47], s3 offen lds
  s_add_u32 m0, s85, 57344
  v_mfma_f32_32x32x16_bf16 v[224:239], v[92:95], v[104:107], v[224:239]
  buffer_load_dwordx4 v54, s[48:51], s3 offen lds
  s_add_u32 m0, s85, 58368
  v_mfma_f32_32x32x16_bf16 v[240:255], v[92:95], v[108:111], v[240:255]
  buffer_load_dwordx4 v55, s[48:51], s3 offen lds
  s_waitcnt lgkmcnt(7)
  v_mfma_f32_32x32x16_bf16 v[128:143], v[64:67], v[96:99], v[128:143]
  ds_read_b128 v[104:107], v7 offset:0
  ds_read_b64_tr_b16 v[80:81], v2 offset:4096
  s_waitcnt lgkmcnt(8)
  v_mfma_f32_32x32x16_bf16 v[144:159], v[64:67], v[100:103], v[144:159]
  ds_read_b64_tr_b16 v[82:83], v2 offset:5120
  ds_read_b128 v[108:111], v7 offset:4096
  s_waitcnt lgkmcnt(8)
  v_mfma_f32_32x32x16_bf16 v[160:175], v[68:71], v[96:99], v[160:175]
  ds_read_b64_tr_b16 v[84:85], v3 offset:4096
  ds_read_b64_tr_b16 v[86:87], v3 offset:5120
  v_mfma_f32_32x32x16_bf16 v[176:191], v[68:71], v[100:103], v[176:191]
  ds_read_b64_tr_b16 v[88:89], v4 offset:4096
  ds_read_b64_tr_b16 v[90:91], v4 offset:5120
  s_add_u32 m0, s78, 98304
  s_add_u32 s70, s76, 0
  s_waitcnt lgkmcnt(10)
  v_mfma_f32_32x32x16_bf16 v[192:207], v[72:75], v[96:99], v[192:207]
  ds_read_b64_tr_b16 v[92:93], v5 offset:4096
  ds_read_b64_tr_b16 v[94:95], v5 offset:5120
  buffer_load_dwordx4 v14, s[52:55], s70 offen lds
  s_add_u32 m0, s78, 99328
  s_add_u32 s70, s76, 8192
  v_mfma_f32_32x32x16_bf16 v[208:223], v[72:75], v[100:103], v[208:223]
  buffer_load_dwordx4 v14, s[52:55], s70 offen lds
  s_add_u32 m0, s78, 100352
  s_add_u32 s70, s76, 16384
  s_waitcnt lgkmcnt(10)
  v_mfma_f32_32x32x16_bf16 v[224:239], v[76:79], v[96:99], v[224:239]
  buffer_load_dwordx4 v14, s[52:55], s70 offen lds
  s_add_u32 m0, s78, 101376
  s_add_u32 s70, s76, 24576
  v_mfma_f32_32x32x16_bf16 v[240:255], v[76:79], v[100:103], v[240:255]
  buffer_load_dwordx4 v14, s[52:55], s70 offen lds
  s_waitcnt vmcnt(16)
  s_waitcnt lgkmcnt(0)
  s_barrier
  v_mfma_f32_32x32x16_bf16 v[128:143], v[80:83], v[104:107], v[128:143]
  ds_read_b128 v[96:99], v8 offset:0
  ds_read_b64_tr_b16 v[64:65], v2 offset:16384
  v_mfma_f32_32x32x16_bf16 v[144:159], v[80:83], v[108:111], v[144:159]
  ds_read_b64_tr_b16 v[66:67], v2 offset:17408
  ds_read_b128 v[100:103], v8 offset:4096
  v_mfma_f32_32x32x16_bf16 v[160:175], v[84:87], v[104:107], v[160:175]
  ds_read_b64_tr_b16 v[68:69], v3 offset:16384
  ds_read_b64_tr_b16 v[70:71], v3 offset:17408
  v_mfma_f32_32x32x16_bf16 v[176:191], v[84:87], v[108:111], v[176:191]
  ds_read_b64_tr_b16 v[72:73], v4 offset:16384
  ds_read_b64_tr_b16 v[74:75], v4 offset:17408
  v_mfma_f32_32x32x16_bf16 v[192:207], v[88:91], v[104:107], v[192:207]
  ds_read_b64_tr_b16 v[76:77], v5 offset:16384
  ds_read_b64_tr_b16 v[78:79], v5 offset:17408
  s_add_u32 m0, s78, 0
  s_add_u32 s70, s76, 32768
  v_mfma_f32_32x32x16_bf16 v[208:223], v[88:91], v[108:111], v[208:223]
  buffer_load_dwordx4 v14, s[52:55], s70 offen lds
  s_add_u32 m0, s78, 1024
  s_add_u32 s70, s76, 40960
  v_mfma_f32_32x32x16_bf16 v[224:239], v[92:95], v[104:107], v[224:239]
  buffer_load_dwordx4 v14, s[52:55], s70 offen lds
  s_add_u32 m0, s78, 2048
  s_add_u32 s70, s76, 49152
  v_mfma_f32_32x32x16_bf16 v[240:255], v[92:95], v[108:111], v[240:255]
  buffer_load_dwordx4 v14, s[52:55], s70 offen lds
  s_waitcnt lgkmcnt(7)
  v_mfma_f32_32x32x16_bf16 v[128:143], v[64:67], v[96:99], v[128:143]
  ds_read_b128 v[104:107], v9 offset:0
  ds_read_b64_tr_b16 v[80:81], v2 offset:20480
  s_waitcnt lgkmcnt(8)
  v_mfma_f32_32x32x16_bf16 v[144:159], v[64:67], v[100:103], v[144:159]
  ds_read_b64_tr_b16 v[82:83], v2 offset:21504
  ds_read_b128 v[108:111], v9 offset:4096
  s_waitcnt lgkmcnt(8)
  v_mfma_f32_32x32x16_bf16 v[160:175], v[68:71], v[96:99], v[160:175]
  ds_read_b64_tr_b16 v[84:85], v3 offset:20480
  ds_read_b64_tr_b16 v[86:87], v3 offset:21504
  v_mfma_f32_32x32x16_bf16 v[176:191], v[68:71], v[100:103], v[176:191]
  ds_read_b64_tr_b16 v[88:89], v4 offset:20480
  ds_read_b64_tr_b16 v[90:91], v4 offset:21504
  s_waitcnt lgkmcnt(10)
  v_mfma_f32_32x32x16_bf16 v[192:207], v[72:75], v[96:99], v[192:207]
  ds_read_b64_tr_b16 v[92:93], v5 offset:20480
  ds_read_b64_tr_b16 v[94:95], v5 offset:21504
  v_mfma_f32_32x32x16_bf16 v[208:223], v[72:75], v[100:103], v[208:223]
  s_waitcnt lgkmcnt(10)
  v_mfma_f32_32x32x16_bf16 v[224:239], v[76:79], v[96:99], v[224:239]
  s_add_u32 m0, s78, 3072
  s_add_u32 s70, s76, 57344
  v_mfma_f32_32x32x16_bf16 v[240:255], v[76:79], v[100:103], v[240:255]
  buffer_load_dwordx4 v14, s[52:55], s70 offen lds
  s_waitcnt vmcnt(12)
  s_waitcnt lgkmcnt(0)
  s_barrier
  v_mfma_f32_32x32x16_bf16 v[128:143], v[80:83], v[104:107], v[128:143]
  ds_read_b128 v[96:99], v6 offset:16384
  ds_read_b64_tr_b16 v[64:65], v2 offset:32768
  v_mfma_f32_32x32x16_bf16 v[144:159], v[80:83], v[108:111], v[144:159]
  ds_read_b64_tr_b16 v[66:67], v2 offset:33792
  ds_read_b128 v[100:103], v6 offset:20480
  v_mfma_f32_32x32x16_bf16 v[160:175], v[84:87], v[104:107], v[160:175]
  ds_read_b64_tr_b16 v[68:69], v3 offset:32768
  ds_read_b64_tr_b16 v[70:71], v3 offset:33792
  v_mfma_f32_32x32x16_bf16 v[176:191], v[84:87], v[108:111], v[176:191]
  ds_read_b64_tr_b16 v[72:73], v4 offset:32768
  ds_read_b64_tr_b16 v[74:75], v4 offset:33792
  s_add_u32 m0, s78, 16384
  s_add_u32 s70, s76, 65536
  v_mfma_f32_32x32x16_bf16 v[192:207], v[88:91], v[104:107], v[192:207]
  ds_read_b64_tr_b16 v[76:77], v5 offset:32768
  ds_read_b64_tr_b16 v[78:79], v5 offset:33792
  buffer_load_dwordx4 v14, s[52:55], s70 offen lds
  s_add_u32 m0, s78, 17408
  s_add_u32 s70, s76, 73728
  v_mfma_f32_32x32x16_bf16 v[208:223], v[88:91], v[108:111], v[208:223]
  buffer_load_dwordx4 v14, s[52:55], s70 offen lds
  s_add_u32 m0, s78, 18432
  s_add_u32 s70, s76, 81920
  v_mfma_f32_32x32x16_bf16 v[224:239], v[92:95], v[104:107], v[224:239]
  buffer_load_dwordx4 v14, s[52:55], s70 offen lds
  s_add_u32 m0, s78, 19456
  s_add_u32 s70, s76, 90112
  v_mfma_f32_32x32x16_bf16 v[240:255], v[92:95], v[108:111], v[240:255]
  buffer_load_dwordx4 v14, s[52:55], s70 offen lds
  s_waitcnt lgkmcnt(7)
  v_mfma_f32_32x32x16_bf16 v[128:143], v[64:67], v[96:99], v[128:143]
  ds_read_b128 v[104:107], v7 offset:16384
  ds_read_b64_tr_b16 v[80:81], v2 offset:36864
  s_waitcnt lgkmcnt(8)
  v_mfma_f32_32x32x16_bf16 v[144:159], v[64:67], v[100:103], v[144:159]
  ds_read_b64_tr_b16 v[82:83], v2 offset:37888
  ds_read_b128 v[108:111], v7 offset:20480
  s_waitcnt lgkmcnt(8)
  v_mfma_f32_32x32x16_bf16 v[160:175], v[68:71], v[96:99], v[160:175]
  ds_read_b64_tr_b16 v[84:85], v3 offset:36864
  ds_read_b64_tr_b16 v[86:87], v3 offset:37888
  v_mfma_f32_32x32x16_bf16 v[176:191], v[68:71], v[100:103], v[176:191]
  ds_read_b64_tr_b16 v[88:89], v4 offset:36864
  ds_read_b64_tr_b16 v[90:91], v4 offset:37888
  s_add_u32 m0, s78, 65536
  s_add_u32 s70, s76, 98304
  s_waitcnt lgkmcnt(10)
  v_mfma_f32_32x32x16_bf16 v[192:207], v[72:75], v[96:99], v[192:207]
  ds_read_b64_tr_b16 v[92:93], v5 offset:36864
  ds_read_b64_tr_b16 v[94:95], v5 offset:37888
  buffer_load_dwordx4 v14, s[52:55], s70 offen lds
  s_add_u32 m0, s78, 66560
  s_add_u32 s70, s76, 106496
  v_mfma_f32_32x32x16_bf16 v[208:223], v[72:75], v[100:103], v[208:223]
  buffer_load_dwordx4 v14, s[52:55], s70 offen lds
  s_add_u32 m0, s78, 67584
  s_add_u32 s70, s76, 114688
  s_waitcnt lgkmcnt(10)
  v_mfma_f32_32x32x16_bf16 v[224:239], v[76:79], v[96:99], v[224:239]
  buffer_load_dwordx4 v14, s[52:55], s70 offen lds
  s_add_u32 m0, s78, 68608
  s_add_u32 s70, s76, 122880
  v_mfma_f32_32x32x16_bf16 v[240:255], v[76:79], v[100:103], v[240:255]
  buffer_load_dwordx4 v14, s[52:55], s70 offen lds
  s_waitcnt vmcnt(16)
  s_waitcnt lgkmcnt(0)
  s_barrier
  v_mfma_f32_32x32x16_bf16 v[128:143], v[80:83], v[104:107], v[128:143]
  ds_read_b128 v[96:99], v8 offset:16384
  ds_read_b64_tr_b16 v[64:65], v2 offset:49152
  v_mfma_f32_32x32x16_bf16 v[144:159], v[80:83], v[108:111], v[144:159]
  ds_read_b64_tr_b16 v[66:67], v2 offset:50176
  ds_read_b128 v[100:103], v8 offset:20480
  v_mfma_f32_32x32x16_bf16 v[160:175], v[84:87], v[104:107], v[160:175]
  ds_read_b64_tr_b16 v[68:69], v3 offset:49152
  ds_read_b64_tr_b16 v[70:71], v3 offset:50176
  v_mfma_f32_32x32x16_bf16 v[176:191], v[84:87], v[108:111], v[176:191]
  ds_read_b64_tr_b16 v[72:73], v4 offset:49152
  ds_read_b64_tr_b16 v[74:75], v4 offset:50176
  v_mfma_f32_32x32x16_bf16 v[192:207], v[88:91], v[104:107], v[192:207]
  ds_read_b64_tr_b16 v[76:77], v5 offset:49152
  ds_read_b64_tr_b16 v[78:79], v5 offset:50176
  s_add_u32 m0, s78, 32768
  s_add_u32 s70, s76, 131072
  v_mfma_f32_32x32x16_bf16 v[208:223], v[88:91], v[108:111], v[208:223]
  buffer_load_dwordx4 v14, s[52:55], s70 offen lds
  s_add_u32 m0, s78, 33792
  s_add_u32 s70, s76, 139264
  v_mfma_f32_32x32x16_bf16 v[224:239], v[92:95], v[104:107], v[224:239]
  buffer_load_dwordx4 v14, s[52:55], s70 offen lds
  s_add_u32 m0, s78, 34816
  s_add_u32 s70, s76, 147456
  v_mfma_f32_32x32x16_bf16 v[240:255], v[92:95], v[108:111], v[240:255]
  buffer_load_dwordx4 v14, s[52:55], s70 offen lds
  s_waitcnt lgkmcnt(7)
  v_mfma_f32_32x32x16_bf16 v[128:143], v[64:67], v[96:99], v[128:143]
  ds_read_b128 v[104:107], v9 offset:16384
  ds_read_b64_tr_b16 v[80:81], v2 offset:53248
  s_waitcnt lgkmcnt(8)
  v_mfma_f32_32x32x16_bf16 v[144:159], v[64:67], v[100:103], v[144:159]
  ds_read_b64_tr_b16 v[82:83], v2 offset:54272
  ds_read_b128 v[108:111], v9 offset:20480
  s_waitcnt lgkmcnt(8)
  v_mfma_f32_32x32x16_bf16 v[160:175], v[68:71], v[96:99], v[160:175]
  ds_read_b64_tr_b16 v[84:85], v3 offset:53248
  ds_read_b64_tr_b16 v[86:87], v3 offset:54272
  v_mfma_f32_32x32x16_bf16 v[176:191], v[68:71], v[100:103], v[176:191]
  ds_read_b64_tr_b16 v[88:89], v4 offset:53248
  ds_read_b64_tr_b16 v[90:91], v4 offset:54272
  s_waitcnt lgkmcnt(10)
  v_mfma_f32_32x32x16_bf16 v[192:207], v[72:75], v[96:99], v[192:207]
  ds_read_b64_tr_b16 v[92:93], v5 offset:53248
  ds_read_b64_tr_b16 v[94:95], v5 offset:54272
  v_mfma_f32_32x32x16_bf16 v[208:223], v[72:75], v[100:103], v[208:223]
  s_waitcnt lgkmcnt(10)
  v_mfma_f32_32x32x16_bf16 v[224:239], v[76:79], v[96:99], v[224:239]
  s_add_u32 m0, s78, 35840
  s_add_u32 s70, s76, 155648
  v_mfma_f32_32x32x16_bf16 v[240:255], v[76:79], v[100:103], v[240:255]
  buffer_load_dwordx4 v14, s[52:55], s70 offen lds
  s_waitcnt lgkmcnt(0)
  s_barrier
  v_mfma_f32_32x32x16_bf16 v[128:143], v[80:83], v[104:107], v[128:143]
  v_mfma_f32_32x32x16_bf16 v[144:159], v[80:83], v[108:111], v[144:159]
  v_mfma_f32_32x32x16_bf16 v[160:175], v[84:87], v[104:107], v[160:175]
  s_nop 9
  v_max_f32 v128, 0, v128
  v_max_f32 v129, 0, v129
  v_max_f32 v130, 0, v130
  v_max_f32 v131, 0, v131
  v_max_f32 v132, 0, v132
  v_max_f32 v133, 0, v133
  v_max_f32 v134, 0, v134
  v_max_f32 v135, 0, v135
  v_mul_f32 v128, v128, v136
  v_mul_f32 v129, v129, v137
  v_mul_f32 v130, v130, v138
  v_mul_f32 v131, v131, v139
  v_mul_f32 v132, v132, v140
  v_mul_f32 v133, v133, v141
  v_mul_f32 v134, v134, v142
  v_mul_f32 v135, v135, v143
  v_cvt_pk_bf16_f32 v16, v128, v129
  v_cvt_pk_bf16_f32 v17, v130, v131
  v_cvt_pk_bf16_f32 v18, v132, v133
  v_cvt_pk_bf16_f32 v19, v134, v135
  buffer_store_dwordx4 v[16:19], v15, s[56:59], s82 offen offset:0 sc1
  v_mfma_f32_32x32x16_bf16 v[176:191], v[84:87], v[108:111], v[176:191]
  v_max_f32 v144, 0, v144
  v_max_f32 v145, 0, v145
  v_max_f32 v146, 0, v146
  v_max_f32 v147, 0, v147
  v_max_f32 v148, 0, v148
  v_max_f32 v149, 0, v149
  v_max_f32 v150, 0, v150
  v_max_f32 v151, 0, v151
  v_mul_f32 v144, v144, v152
  v_mul_f32 v145, v145, v153
  v_mul_f32 v146, v146, v154
  v_mul_f32 v147, v147, v155
  v_mul_f32 v148, v148, v156
  v_mul_f32 v149, v149, v157
  v_mul_f32 v150, v150, v158
  v_mul_f32 v151, v151, v159
  v_cvt_pk_bf16_f32 v20, v144, v145
  v_cvt_pk_bf16_f32 v21, v146, v147
  v_cvt_pk_bf16_f32 v22, v148, v149
  v_cvt_pk_bf16_f32 v23, v150, v151
  buffer_store_dwordx4 v[20:23], v15, s[56:59], s83 offen offset:0 sc1
  v_mfma_f32_32x32x16_bf16 v[192:207], v[88:91], v[104:107], v[192:207]
  v_max_f32 v160, 0, v160
  v_max_f32 v161, 0, v161
  v_max_f32 v162, 0, v162
  v_max_f32 v163, 0, v163
  v_max_f32 v164, 0, v164
  v_max_f32 v165, 0, v165
  v_max_f32 v166, 0, v166
  v_max_f32 v167, 0, v167
  v_mul_f32 v160, v160, v168
  v_mul_f32 v161, v161, v169
  v_mul_f32 v162, v162, v170
  v_mul_f32 v163, v163, v171
  v_mul_f32 v164, v164, v172
  v_mul_f32 v165, v165, v173
  v_mul_f32 v166, v166, v174
  v_mul_f32 v167, v167, v175
  v_cvt_pk_bf16_f32 v24, v160, v161
  v_cvt_pk_bf16_f32 v25, v162, v163
  v_cvt_pk_bf16_f32 v26, v164, v165
  v_cvt_pk_bf16_f32 v27, v166, v167
  buffer_store_dwordx4 v[24:27], v15, s[56:59], s82 offen offset:1024 sc1
  v_mfma_f32_32x32x16_bf16 v[208:223], v[88:91], v[108:111], v[208:223]
  v_max_f32 v176, 0, v176
  v_max_f32 v177, 0, v177
  v_max_f32 v178, 0, v178
  v_max_f32 v179, 0, v179
  v_max_f32 v180, 0, v180
  v_max_f32 v181, 0, v181
  v_max_f32 v182, 0, v182
  v_max_f32 v183, 0, v183
  v_mul_f32 v176, v176, v184
  v_mul_f32 v177, v177, v185
  v_mul_f32 v178, v178, v186
  v_mul_f32 v179, v179, v187
  v_mul_f32 v180, v180, v188
  v_mul_f32 v181, v181, v189
  v_mul_f32 v182, v182, v190
  v_mul_f32 v183, v183, v191
  v_cvt_pk_bf16_f32 v28, v176, v177
  v_cvt_pk_bf16_f32 v29, v178, v179
  v_cvt_pk_bf16_f32 v30, v180, v181
  v_cvt_pk_bf16_f32 v31, v182, v183
  buffer_store_dwordx4 v[28:31], v15, s[56:59], s83 offen offset:1024 sc1
  v_mfma_f32_32x32x16_bf16 v[224:239], v[92:95], v[104:107], v[224:239]
  v_max_f32 v192, 0, v192
  v_max_f32 v193, 0, v193
  v_max_f32 v194, 0, v194
  v_max_f32 v195, 0, v195
  v_max_f32 v196, 0, v196
  v_max_f32 v197, 0, v197
  v_max_f32 v198, 0, v198
  v_max_f32 v199, 0, v199
  v_mul_f32 v192, v192, v200
  v_mul_f32 v193, v193, v201
  v_mul_f32 v194, v194, v202
  v_mul_f32 v195, v195, v203
  v_mul_f32 v196, v196, v204
  v_mul_f32 v197, v197, v205
  v_mul_f32 v198, v198, v206
  v_mul_f32 v199, v199, v207
  v_cvt_pk_bf16_f32 v32, v192, v193
  v_cvt_pk_bf16_f32 v33, v194, v195
  v_cvt_pk_bf16_f32 v34, v196, v197
  v_cvt_pk_bf16_f32 v35, v198, v199
  buffer_store_dwordx4 v[32:35], v15, s[56:59], s82 offen offset:2048 sc1
  v_mfma_f32_32x32x16_bf16 v[240:255], v[92:95], v[108:111], v[240:255]
  v_max_f32 v208, 0, v208
  v_max_f32 v209, 0, v209
  v_max_f32 v210, 0, v210
  v_max_f32 v211, 0, v211
  v_max_f32 v212, 0, v212
  v_max_f32 v213, 0, v213
  v_max_f32 v214, 0, v214
  v_max_f32 v215, 0, v215
  v_mul_f32 v208, v208, v216
  v_mul_f32 v209, v209, v217
  v_mul_f32 v210, v210, v218
  v_mul_f32 v211, v211, v219
  v_mul_f32 v212, v212, v220
  v_mul_f32 v213, v213, v221
  v_mul_f32 v214, v214, v222
  v_mul_f32 v215, v215, v223
  v_cvt_pk_bf16_f32 v36, v208, v209
  v_cvt_pk_bf16_f32 v37, v210, v211
  v_cvt_pk_bf16_f32 v38, v212, v213
  v_cvt_pk_bf16_f32 v39, v214, v215
  buffer_store_dwordx4 v[36:39], v15, s[56:59], s83 offen offset:2048 sc1
  v_max_f32 v224, 0, v224
  v_max_f32 v225, 0, v225
  v_max_f32 v226, 0, v226
  v_max_f32 v227, 0, v227
  v_max_f32 v228, 0, v228
  v_max_f32 v229, 0, v229
  v_max_f32 v230, 0, v230
  v_max_f32 v231, 0, v231
  v_mul_f32 v224, v224, v232
  v_mul_f32 v225, v225, v233
  v_mul_f32 v226, v226, v234
  v_mul_f32 v227, v227, v235
  v_mul_f32 v228, v228, v236
  v_mul_f32 v229, v229, v237
  v_mul_f32 v230, v230, v238
  v_mul_f32 v231, v231, v239
  v_cvt_pk_bf16_f32 v40, v224, v225
  v_cvt_pk_bf16_f32 v41, v226, v227
  v_cvt_pk_bf16_f32 v42, v228, v229
  v_cvt_pk_bf16_f32 v43, v230, v231
  buffer_store_dwordx4 v[40:43], v15, s[56:59], s82 offen offset:3072 sc1
  v_max_f32 v240, 0, v240
  v_max_f32 v241, 0, v241
  v_max_f32 v242, 0, v242
  v_max_f32 v243, 0, v243
  v_max_f32 v244, 0, v244
  v_max_f32 v245, 0, v245
  v_max_f32 v246, 0, v246
  v_max_f32 v247, 0, v247
  v_mul_f32 v240, v240, v248
  v_mul_f32 v241, v241, v249
  v_mul_f32 v242, v242, v250
  v_mul_f32 v243, v243, v251
  v_mul_f32 v244, v244, v252
  v_mul_f32 v245, v245, v253
  v_mul_f32 v246, v246, v254
  v_mul_f32 v247, v247, v255
  v_cvt_pk_bf16_f32 v44, v240, v241
  v_cvt_pk_bf16_f32 v45, v242, v243
  v_cvt_pk_bf16_f32 v46, v244, v245
  v_cvt_pk_bf16_f32 v47, v246, v247
  buffer_store_dwordx4 v[44:47], v15, s[56:59], s83 offen offset:3072 sc1
  s_add_u32 m0, s78, 49152
  s_add_u32 s70, s76, 163840
  buffer_load_dwordx4 v14, s[52:55], s70 offen lds
  s_add_u32 m0, s78, 50176
  s_add_u32 s70, s76, 172032
  buffer_load_dwordx4 v14, s[52:55], s70 offen lds
  s_add_u32 m0, s78, 51200
  s_add_u32 s70, s76, 180224
  buffer_load_dwordx4 v14, s[52:55], s70 offen lds
  s_add_u32 m0, s78, 52224
  s_add_u32 s70, s76, 188416
  buffer_load_dwordx4 v14, s[52:55], s70 offen lds
  s_add_u32 m0, s78, 81920
  s_add_u32 s70, s76, 196608
  buffer_load_dwordx4 v14, s[52:55], s70 offen lds
  s_add_u32 m0, s78, 82944
  s_add_u32 s70, s76, 204800
  buffer_load_dwordx4 v14, s[52:55], s70 offen lds
  s_add_u32 m0, s78, 83968
  s_add_u32 s70, s76, 212992
  buffer_load_dwordx4 v14, s[52:55], s70 offen lds
  s_add_u32 m0, s78, 84992
  s_add_u32 s70, s76, 221184
  buffer_load_dwordx4 v14, s[52:55], s70 offen lds
  s_waitcnt vmcnt(34)
  ds_read_b64_tr_b16 v[80:81], v12 offset:32768
  ds_read_b64_tr_b16 v[82:83], v12 offset:33792
  ds_read_b64_tr_b16 v[84:85], v13 offset:32768
  ds_read_b64_tr_b16 v[86:87], v13 offset:33792
  s_waitcnt vmcnt(32)
  ds_read_b64_tr_b16 v[88:89], v12 offset:34816
  ds_read_b64_tr_b16 v[90:91], v12 offset:35840
  ds_read_b64_tr_b16 v[92:93], v13 offset:34816
  ds_read_b64_tr_b16 v[94:95], v13 offset:35840
  s_waitcnt vmcnt(30)
  ds_read_b64_tr_b16 v[96:97], v10 offset:0
  ds_read_b64_tr_b16 v[98:99], v10 offset:1024
  ds_read_b64_tr_b16 v[100:101], v11 offset:0
  ds_read_b64_tr_b16 v[102:103], v11 offset:1024
  s_waitcnt vmcnt(28)
  ds_read_b64_tr_b16 v[104:105], v10 offset:2048
  ds_read_b64_tr_b16 v[106:107], v10 offset:3072
  ds_read_b64_tr_b16 v[108:109], v11 offset:2048
  ds_read_b64_tr_b16 v[110:111], v11 offset:3072
  s_waitcnt vmcnt(26)
  ds_read_b64_tr_b16 v[112:113], v10 offset:16384
  ds_read_b64_tr_b16 v[114:115], v10 offset:17408
  ds_read_b64_tr_b16 v[116:117], v11 offset:16384
  ds_read_b64_tr_b16 v[118:119], v11 offset:17408
  s_waitcnt vmcnt(24)
  ds_read_b64_tr_b16 v[120:121], v10 offset:18432
  ds_read_b64_tr_b16 v[122:123], v10 offset:19456
  ds_read_b64_tr_b16 v[124:125], v11 offset:18432
  ds_read_b64_tr_b16 v[126:127], v11 offset:19456
  s_waitcnt vmcnt(22)
  ds_read_b64_tr_b16 v[128:129], v12 offset:0
  ds_read_b64_tr_b16 v[130:131], v12 offset:1024
  ds_read_b64_tr_b16 v[132:133], v13 offset:0
  ds_read_b64_tr_b16 v[134:135], v13 offset:1024
  s_waitcnt vmcnt(20)
  ds_read_b64_tr_b16 v[136:137], v12 offset:2048
  ds_read_b64_tr_b16 v[138:139], v12 offset:3072
  ds_read_b64_tr_b16 v[140:141], v13 offset:2048
  ds_read_b64_tr_b16 v[142:143], v13 offset:3072
  s_waitcnt vmcnt(18)
  ds_read_b64_tr_b16 v[144:145], v10 offset:32768
  ds_read_b64_tr_b16 v[146:147], v10 offset:33792
  ds_read_b64_tr_b16 v[148:149], v11 offset:32768
  ds_read_b64_tr_b16 v[150:151], v11 offset:33792
  s_waitcnt vmcnt(16)
  ds_read_b64_tr_b16 v[152:153], v10 offset:34816
  ds_read_b64_tr_b16 v[154:155], v10 offset:35840
  ds_read_b64_tr_b16 v[156:157], v11 offset:34816
  ds_read_b64_tr_b16 v[158:159], v11 offset:35840
  s_waitcnt vmcnt(8)
  v_mov_b32 v16, 1
  s_mov_b64 exec, 1
  buffer_atomic_add v16, off, s[56:59], s84 sc1
  s_mov_b64 exec, -1
  s_mul_i32 s70, s39, 224
  s_mul_i32 s71, s34, 28
  s_add_u32 s70, s70, s71
  s_mul_i32 s71, s79, 14
  s_add_u32 s4, s70, s71
  s_sub_u32 s8, s70, s71
  s_add_u32 s8, s8, 14
  s_lshl_b32 s4, s4, 10
  s_add_u32 s4, s4, 2097152
  s_lshl_b32 s8, s8, 10
  s_add_u32 s8, s8, 2097152
  s_add_u32 s5, s4, 4096
  s_add_u32 s6, s4, 8192
  s_add_u32 s7, s4, 12288
  s_add_u32 s12, s4, 114688
  s_add_u32 s13, s4, 118784
  s_add_u32 s14, s4, 122880
  s_add_u32 s15, s4, 126976
  s_add_u32 s9, s8, 4096
  s_add_u32 s10, s8, 8192
  s_add_u32 s11, s8, 12288
  s_add_u32 s16, s8, 114688
  s_add_u32 s17, s8, 118784
  s_add_u32 s18, s8, 122880
  s_add_u32 s19, s8, 126976
  s_lshl_b32 s87, s39, 2
  s_add_u32 s87, s87, s34
  s_lshl_b32 s86, s87, 7
  s_add_u32 s86, s86, 11534336
  s_lshl_b32 s87, s87, 8
  s_add_u32 s87, s87, 11550720
  v_and_b32 v8, 15, v1
  v_lshlrev_b32 v8, 3, v8
  s_waitcnt lgkmcnt(0)
  s_add_u32 m0, s78, 98304
  s_add_u32 s70, s77, 0
  buffer_load_dwordx4 v14, s[52:55], s70 offen lds
  s_add_u32 m0, s78, 99328
  s_add_u32 s70, s77, 8192
  buffer_load_dwordx4 v14, s[52:55], s70 offen lds
  s_add_u32 m0, s78, 100352
  s_add_u32 s70, s77, 16384
  buffer_load_dwordx4 v14, s[52:55], s70 offen lds
  s_add_u32 m0, s78, 101376
  s_add_u32 s70, s77, 24576
  buffer_load_dwordx4 v14, s[52:55], s70 offen lds
  s_add_u32 m0, s78, 0
  s_add_u32 s70, s77, 32768
  buffer_load_dwordx4 v14, s[52:55], s70 offen lds
  s_add_u32 m0, s78, 1024
  s_add_u32 s70, s77, 40960
  buffer_load_dwordx4 v14, s[52:55], s70 offen lds
  s_add_u32 m0, s78, 2048
  s_add_u32 s70, s77, 49152
  buffer_load_dwordx4 v14, s[52:55], s70 offen lds
  s_add_u32 m0, s78, 3072
  s_add_u32 s70, s77, 57344
  buffer_load_dwordx4 v14, s[52:55], s70 offen lds
  s_add_u32 m0, s78, 16384
  s_add_u32 s70, s77, 65536
  buffer_load_dwordx4 v14, s[52:55], s70 offen lds
  s_add_u32 m0, s78, 17408
  s_add_u32 s70, s77, 73728
  buffer_load_dwordx4 v14, s[52:55], s70 offen lds
  s_add_u32 m0, s78, 18432
  s_add_u32 s70, s77, 81920
  buffer_load_dwordx4 v14, s[52:55], s70 offen lds
  s_add_u32 m0, s78, 19456
  s_add_u32 s70, s77, 90112
  buffer_load_dwordx4 v14, s[52:55], s70 offen lds
  s_add_u32 m0, s78, 65536
  s_add_u32 s70, s77, 98304
  buffer_load_dwordx4 v14, s[52:55], s70 offen lds
  s_add_u32 m0, s78, 66560
  s_add_u32 s70, s77, 106496
  buffer_load_dwordx4 v14, s[52:55], s70 offen lds
  s_add_u32 m0, s78, 67584
  s_add_u32 s70, s77, 114688
  buffer_load_dwordx4 v14, s[52:55], s70 offen lds
  s_add_u32 m0, s78, 68608
  s_add_u32 s70, s77, 122880
  buffer_load_dwordx4 v14, s[52:55], s70 offen lds
  v_mov_b32 v2, 8
  s_mov_b64 exec, 1
  v_mov_b32 v2, 0
  buffer_atomic_or v2, off, s[56:59], s87 sc0 sc1
  s_mov_b64 exec, -1
  s_waitcnt vmcnt(18)
  ds_read_b64_tr_b16 v[160:161], v10 offset:49152
  ds_read_b64_tr_b16 v[162:163], v10 offset:50176
  ds_read_b64_tr_b16 v[164:165], v11 offset:49152
  ds_read_b64_tr_b16 v[166:167], v11 offset:50176
  ds_read_b64_tr_b16 v[168:169], v10 offset:51200
  ds_read_b64_tr_b16 v[170:171], v10 offset:52224
  ds_read_b64_tr_b16 v[172:173], v11 offset:51200
  ds_read_b64_tr_b16 v[174:175], v11 offset:52224
  ds_read_b64_tr_b16 v[176:177], v12 offset:16384
  ds_read_b64_tr_b16 v[178:179], v12 offset:17408
  ds_read_b64_tr_b16 v[180:181], v13 offset:16384
  ds_read_b64_tr_b16 v[182:183], v13 offset:17408
  ds_read_b64_tr_b16 v[184:185], v12 offset:18432
  ds_read_b64_tr_b16 v[186:187], v12 offset:19456
  ds_read_b64_tr_b16 v[188:189], v13 offset:18432
  ds_read_b64_tr_b16 v[190:191], v13 offset:19456
  s_add_u32 m0, s78, 32768
  s_add_u32 s70, s77, 131072
  buffer_load_dwordx4 v14, s[52:55], s70 offen lds
  s_add_u32 m0, s78, 33792
  s_add_u32 s70, s77, 139264
  buffer_load_dwordx4 v14, s[52:55], s70 offen lds
  s_add_u32 m0, s78, 34816
  s_add_u32 s70, s77, 147456
  buffer_load_dwordx4 v14, s[52:55], s70 offen lds
  s_add_u32 m0, s78, 35840
  s_add_u32 s70, s77, 155648
  buffer_load_dwordx4 v14, s[52:55], s70 offen lds
  s_waitcnt lgkmcnt(0)
  s_add_u32 m0, s78, 49152
  s_add_u32 s70, s77, 163840
  buffer_load_dwordx4 v14, s[52:55], s70 offen lds
  s_add_u32 m0, s78, 50176
  s_add_u32 s70, s77, 172032
  buffer_load_dwordx4 v14, s[52:55], s70 offen lds
  s_add_u32 m0, s78, 51200
  s_add_u32 s70, s77, 180224
  buffer_load_dwordx4 v14, s[52:55], s70 offen lds
  s_add_u32 m0, s78, 52224
  s_add_u32 s70, s77, 188416
  buffer_load_dwordx4 v14, s[52:55], s70 offen lds
  s_add_u32 m0, s78, 81920
  s_add_u32 s70, s77, 196608
  buffer_load_dwordx4 v14, s[52:55], s70 offen lds
  s_add_u32 m0, s78, 82944
  s_add_u32 s70, s77, 204800
  buffer_load_dwordx4 v14, s[52:55], s70 offen lds
  s_add_u32 m0, s78, 83968
  s_add_u32 s70, s77, 212992
  buffer_load_dwordx4 v14, s[52:55], s70 offen lds
  s_add_u32 m0, s78, 84992
  s_add_u32 s70, s77, 221184
  buffer_load_dwordx4 v14, s[52:55], s70 offen lds
  s_waitcnt vmcnt(12)
  v_mov_b32 v17, v2
LG2:
  v_cmp_ne_u32 vcc, 8, v17
  s_cbranch_vccz Lk2
  s_bfm_b64 exec, 1, 0
  s_mov_b32 s69, 4096
Lp1:
  v_mov_b32 v17, 0
  buffer_atomic_or v17, off, s[56:59], s87 sc0 sc1
  s_waitcnt vmcnt(0)
  v_cmp_ne_u32 vcc, 8, v17
  s_cbranch_vccz Lk2
  s_sub_u32 s69, s69, 1
  s_cbranch_scc0 Lp1
Lk2:
  s_mov_b64 exec, -1
  s_nop 0
LG3:
  buffer_load_dwordx4 v[16:19], v15, s[56:59], s4 offen offset:0 sc1
  buffer_load_dwordx4 v[20:23], v15, s[56:59], s4 offen offset:1024 sc1
  buffer_load_dwordx4 v[24:27], v15, s[56:59], s4 offen offset:2048 sc1
  buffer_load_dwordx4 v[28:31], v15, s[56:59], s4 offen offset:3072 sc1
  buffer_load_dwordx4 v[32:35], v15, s[56:59], s5 offen offset:0 sc1
  buffer_load_dwordx4 v[36:39], v15, s[56:59], s5 offen offset:1024 sc1
  buffer_load_dwordx4 v[40:43], v15, s[56:59], s5 offen offset:2048 sc1
  buffer_load_dwordx4 v[44:47], v15, s[56:59], s12 offen offset:0 sc1
  buffer_load_dwordx4 v[48:51], v15, s[56:59], s5 offen offset:3072 sc1
  buffer_load_dwordx4 v[52:55], v15, s[56:59], s12 offen offset:1024 sc1
  buffer_load_dwordx4 v[56:59], v15, s[56:59], s6 offen offset:0 sc1
  buffer_load_dwordx4 v[60:63], v15, s[56:59], s12 offen offset:2048 sc1
  buffer_load_dwordx4 v[64:67], v15, s[56:59], s6 offen offset:1024 sc1
  buffer_load_dwordx4 v[68:71], v15, s[56:59], s12 offen offset:3072 sc1
  buffer_load_dwordx2 v[6:7], v8, s[56:59], s86 offen sc1
  s_waitcnt vmcnt(14)
  v_mfma_f32_32x32x16_bf16 v[192:207], v[80:83], v[16:19], 0
  v_mfma_f32_32x32x16_bf16 v[224:239], v[84:87], v[16:19], 0
  s_waitcnt vmcnt(13)
  v_mfma_f32_32x32x16_bf16 v[192:207], v[88:91], v[20:23], v[192:207]
  buffer_load_dwordx4 v[16:19], v15, s[56:59], s6 offen offset:2048 sc1
  v_mfma_f32_32x32x16_bf16 v[224:239], v[92:95], v[20:23], v[224:239]
  s_waitcnt vmcnt(13)
  v_mfma_f32_32x32x16_bf16 v[192:207], v[96:99], v[24:27], v[192:207]
  buffer_load_dwordx4 v[20:23], v15, s[56:59], s13 offen offset:0 sc1
  v_mfma_f32_32x32x16_bf16 v[224:239], v[100:103], v[24:27], v[224:239]
  s_waitcnt vmcnt(13)
  v_mfma_f32_32x32x16_bf16 v[192:207], v[104:107], v[28:31], v[192:207]
  buffer_load_dwordx4 v[24:27], v15, s[56:59], s6 offen offset:3072 sc1
  v_mfma_f32_32x32x16_bf16 v[224:239], v[108:111], v[28:31], v[224:239]
  s_waitcnt vmcnt(13)
  v_mfma_f32_32x32x16_bf16 v[192:207], v[112:115], v[32:35], v[192:207]
  buffer_load_dwordx4 v[28:31], v15, s[56:59], s13 offen offset:1024 sc1
  v_mfma_f32_32x32x16_bf16 v[224:239], v[116:119], v[32:35], v[224:239]
  s_waitcnt vmcnt(13)
  v_mfma_f32_32x32x16_bf16 v[192:207], v[120:123], v[36:39], v[192:207]
  buffer_load_dwordx4 v[32:35], v15, s[56:59], s7 offen offset:0 sc1
  v_mfma_f32_32x32x16_bf16 v[224:239], v[124:127], v[36:39], v[224:239]
  s_waitcnt vmcnt(13)
  v_mfma_f32_32x32x16_bf16 v[192:207], v[128:131], v[40:43], v[192:207]
  buffer_load_dwordx4 v[36:39], v15, s[56:59], s13 offen offset:2048 sc1
  v_mfma_f32_32x32x16_bf16 v[224:239], v[132:135], v[40:43], v[224:239]
  s_waitcnt vmcnt(13)
  v_mfma_f32_32x32x16_bf16 v[208:223], v[80:83], v[44:47], 0
  v_mfma_f32_32x32x16_bf16 v[240:255], v[84:87], v[44:47], 0
  s_waitcnt vmcnt(12)
  v_mfma_f32_32x32x16_bf16 v[192:207], v[136:139], v[48:51], v[192:207]
  buffer_load_dwordx4 v[40:43], v15, s[56:59], s7 offen offset:1024 sc1
  v_mfma_f32_32x32x16_bf16 v[224:239], v[140:143], v[48:51], v[224:239]
  buffer_load_dwordx4 v[44:47], v15, s[56:59], s13 offen offset:3072 sc1
  s_waitcnt vmcnt(13)
  v_mfma_f32_32x32x16_bf16 v[208:223], v[88:91], v[52:55], v[208:223]
  v_mfma_f32_32x32x16_bf16 v[240:255], v[92:95], v[52:55], v[240:255]
  s_waitcnt vmcnt(12)
  v_mfma_f32_32x32x16_bf16 v[192:207], v[144:147], v[56:59], v[192:207]
  buffer_load_dwordx4 v[48:51], v15, s[56:59], s8 offen offset:0 sc1
  v_mfma_f32_32x32x16_bf16 v[224:239], v[148:151], v[56:59], v[224:239]
  buffer_load_dwordx4 v[52:55], v15, s[56:59], s14 offen offset:0 sc1
  s_waitcnt vmcnt(13)
  v_mfma_f32_32x32x16_bf16 v[208:223], v[96:99], v[60:63], v[208:223]
  v_mfma_f32_32x32x16_bf16 v[240:255], v[100:103], v[60:63], v[240:255]
  s_waitcnt vmcnt(12)
  v_mfma_f32_32x32x16_bf16 v[192:207], v[152:155], v[64:67], v[192:207]
  buffer_load_dwordx4 v[56:59], v15, s[56:59], s8 offen offset:1024 sc1
  v_mfma_f32_32x32x16_bf16 v[224:239], v[156:159], v[64:67], v[224:239]
  buffer_load_dwordx4 v[60:63], v15, s[56:59], s14 offen offset:1024 sc1
  s_waitcnt vmcnt(13)
  v_mfma_f32_32x32x16_bf16 v[208:223], v[104:107], v[68:71], v[208:223]
  v_mfma_f32_32x32x16_bf16 v[240:255], v[108:111], v[68:71], v[240:255]
  s_waitcnt vmcnt(11)
  v_mfma_f32_32x32x16_bf16 v[192:207], v[160:163], v[16:19], v[192:207]
  buffer_load_dwordx4 v[64:67], v15, s[56:59], s8 offen offset:2048 sc1
  v_mfma_f32_32x32x16_bf16 v[224:239], v[164:167], v[16:19], v[224:239]
  buffer_load_dwordx4 v[68:71], v15, s[56:59], s14 offen offset:2048 sc1
  s_waitcnt vmcnt(12)
  v_mfma_f32_32x32x16_bf16 v[208:223], v[112:115], v[20:23], v[208:223]
  v_mfma_f32_32x32x16_bf16 v[240:255], v[116:119], v[20:23], v[240:255]
  s_waitcnt vmcnt(11)
  v_mfma_f32_32x32x16_bf16 v[192:207], v[168:171], v[24:27], v[192:207]
  buffer_load_dwordx4 v[16:19], v15, s[56:59], s8 offen offset:3072 sc1
  v_mfma_f32_32x32x16_bf16 v[224:239], v[172:175], v[24:27], v[224:239]
  buffer_load_dwordx4 v[20:23], v15, s[56:59], s14 offen offset:3072 sc1
  s_waitcnt vmcnt(12)
  v_mfma_f32_32x32x16_bf16 v[208:223], v[120:123], v[28:31], v[208:223]
  v_mfma_f32_32x32x16_bf16 v[240:255], v[124:127], v[28:31], v[240:255]
  s_waitcnt vmcnt(11)
  v_mfma_f32_32x32x16_bf16 v[192:207], v[176:179], v[32:35], v[192:207]
  buffer_load_dwordx4 v[24:27], v15, s[56:59], s9 offen offset:0 sc1
  buffer_load_dwordx4 v[28:31], v15, s[56:59], s15 offen offset:0 sc1
  v_mfma_f32_32x32x16_bf16 v[224:239], v[180:183], v[32:35], v[224:239]
  ds_read_b64_tr_b16 v[72:73], v12 offset:32768
  ds_read_b64_tr_b16 v[74:75], v12 offset:33792
  s_waitcnt vmcnt(12)
  v_mfma_f32_32x32x16_bf16 v[208:223], v[128:131], v[36:39], v[208:223]
  ds_read_b64_tr_b16 v[76:77], v13 offset:32768
  v_mfma_f32_32x32x16_bf16 v[240:255], v[132:135], v[36:39], v[240:255]
  ds_read_b64_tr_b16 v[78:79], v13 offset:33792
  s_waitcnt vmcnt(11)
  v_mfma_f32_32x32x16_bf16 v[192:207], v[184:187], v[40:43], v[192:207]
  buffer_load_dwordx4 v[32:35], v15, s[56:59], s9 offen offset:1024 sc1
  buffer_load_dwordx4 v[36:39], v15, s[56:59], s15 offen offset:1024 sc1
  v_mfma_f32_32x32x16_bf16 v[224:239], v[188:191], v[40:43], v[224:239]
  ds_read_b64_tr_b16 v[80:81], v12 offset:34816
  ds_read_b64_tr_b16 v[82:83], v12 offset:35840
  s_waitcnt vmcnt(12)
  v_mfma_f32_32x32x16_bf16 v[208:223], v[136:139], v[44:47], v[208:223]
  ds_read_b64_tr_b16 v[84:85], v13 offset:34816
  v_mfma_f32_32x32x16_bf16 v[240:255], v[140:143], v[44:47], v[240:255]
  ds_read_b64_tr_b16 v[86:87], v13 offset:35840
  s_waitcnt vmcnt(11) lgkmcnt(6)
  v_mfma_f32_32x32x16_bf16 v[192:207], v[72:75], v[48:51], v[192:207]
  buffer_load_dwordx4 v[40:43], v15, s[56:59], s9 offen offset:2048 sc1
  buffer_load_dwordx4 v[44:47], v15, s[56:59], s16 offen offset:0 sc1
  s_waitcnt lgkmcnt(4)
  v_mfma_f32_32x32x16_bf16 v[224:239], v[76:79], v[48:51], v[224:239]
  ds_read_b64_tr_b16 v[88:89], v10 offset:0
  ds_read_b64_tr_b16 v[90:91], v10 offset:1024
  s_waitcnt vmcnt(12)
  v_mfma_f32_32x32x16_bf16 v[208:223], v[144:147], v[52:55], v[208:223]
  ds_read_b64_tr_b16 v[92:93], v11 offset:0
  ds_read_b64_tr_b16 v[94:95], v11 offset:1024
  v_mfma_f32_32x32x16_bf16 v[240:255], v[148:151], v[52:55], v[240:255]
  s_lshl_b32 s70, s34, 7
  s_add_u32 s70, s70, 161792
  v_add_u32 v8, s70, v8
  ds_write_b64 v8, v[6:7]
  v_add_u32 v14, s78, v15
  s_waitcnt vmcnt(11) lgkmcnt(7)
  v_mfma_f32_32x32x16_bf16 v[192:207], v[80:83], v[56:59], v[192:207]
  buffer_load_dwordx4 v[48:51], v15, s[56:59], s9 offen offset:3072 sc1
  buffer_load_dwordx4 v[52:55], v15, s[56:59], s16 offen offset:1024 sc1
  s_waitcnt lgkmcnt(5)
  v_mfma_f32_32x32x16_bf16 v[224:239], v[84:87], v[56:59], v[224:239]
  ds_read_b64_tr_b16 v[96:97], v10 offset:2048
  ds_read_b64_tr_b16 v[98:99], v10 offset:3072
  s_waitcnt vmcnt(12)
  v_mfma_f32_32x32x16_bf16 v[208:223], v[152:155], v[60:63], v[208:223]
  ds_read_b64_tr_b16 v[100:101], v11 offset:2048
  ds_read_b64_tr_b16 v[102:103], v11 offset:3072
  v_mfma_f32_32x32x16_bf16 v[240:255], v[156:159], v[60:63], v[240:255]
  s_and_b32 s70, s34, 3
  s_lshr_b32 s71, s34, 2
  v_and_b32 v6, 15, v1
  v_lshrrev_b32 v7, 4, v1
  s_lshl_b32 s75, s70, 4
  s_waitcnt vmcnt(11) lgkmcnt(7)
  v_mfma_f32_32x32x16_bf16 v[192:207], v[88:91], v[64:67], v[192:207]
  buffer_load_dwordx4 v[56:59], v15, s[56:59], s10 offen offset:0 sc1
  buffer_load_dwordx4 v[60:63], v15, s[56:59], s16 offen offset:2048 sc1
  s_waitcnt lgkmcnt(5)
  v_mfma_f32_32x32x16_bf16 v[224:239], v[92:95], v[64:67], v[224:239]
  ds_read_b64_tr_b16 v[104:105], v10 offset:16384
  ds_read_b64_tr_b16 v[106:107], v10 offset:17408
  s_waitcnt vmcnt(12)
  v_mfma_f32_32x32x16_bf16 v[208:223], v[160:163], v[68:71], v[208:223]
  ds_read_b64_tr_b16 v[108:109], v11 offset:16384
  ds_read_b64_tr_b16 v[110:111], v11 offset:17408
  v_mfma_f32_32x32x16_bf16 v[240:255], v[164:167], v[68:71], v[240:255]
  v_add_u32 v8, s75, v6
  s_lshr_b32 s76, s70, 1
  s_lshl_b32 s77, s71, 1
  s_add_u32 s76, s76, s77
  s_lshl_b32 s76, s76, 14
  s_waitcnt vmcnt(11) lgkmcnt(6)
  v_mfma_f32_32x32x16_bf16 v[192:207], v[96:99], v[16:19], v[192:207]
  buffer_load_dwordx4 v[64:67], v15, s[56:59], s10 offen offset:1024 sc1
  buffer_load_dwordx4 v[68:71], v15, s[56:59], s16 offen offset:3072 sc1
  s_waitcnt lgkmcnt(4)
  v_mfma_f32_32x32x16_bf16 v[224:239], v[100:103], v[16:19], v[224:239]
  ds_read_b64_tr_b16 v[112:113], v10 offset:18432
  ds_read_b64_tr_b16 v[114:115], v10 offset:19456
  s_waitcnt vmcnt(12)
  v_mfma_f32_32x32x16_bf16 v[208:223], v[168:171], v[20:23], v[208:223]
  ds_read_b64_tr_b16 v[116:117], v11 offset:18432
  ds_read_b64_tr_b16 v[118:119], v11 offset:19456
  v_mfma_f32_32x32x16_bf16 v[240:255], v[172:175], v[20:23], v[240:255]
  v_and_b32 v2, 31, v8
  v_lshlrev_b32 v2, 4, v2
  v_lshl_add_u32 v2, v7, 10, v2
  v_add_u32 v2, s76, v2
  s_lshl_b32 s77, s71, 2
  s_waitcnt vmcnt(11) lgkmcnt(6)
  v_mfma_f32_32x32x16_bf16 v[192:207], v[104:107], v[24:27], v[192:207]
  buffer_load_dwordx4 v[16:19], v15, s[56:59], s10 offen offset:2048 sc1
  buffer_load_dwordx4 v[20:23], v15, s[56:59], s17 offen offset:0 sc1
  s_waitcnt lgkmcnt(4)
  v_mfma_f32_32x32x16_bf16 v[224:239], v[108:111], v[24:27], v[224:239]
  ds_read_b64_tr_b16 v[120:121], v12 offset:0
  ds_read_b64_tr_b16 v[122:123], v12 offset:1024
  s_waitcnt vmcnt(12)
  v_mfma_f32_32x32x16_bf16 v[208:223], v[176:179], v[28:31], v[208:223]
  ds_read_b64_tr_b16 v[124:125], v13 offset:0
  ds_read_b64_tr_b16 v[126:127], v13 offset:1024
  v_mfma_f32_32x32x16_bf16 v[240:255], v[180:183], v[28:31], v[240:255]
  v_add_u32 v9, s77, v7
  v_bfe_u32 v3, v1, 2, 2
  v_lshl_add_u32 v3, v9, 3, v3
  v_mul_u32_u24 v3, 160, v3
  v_and_b32 v4, 3, v1
  s_waitcnt vmcnt(11) lgkmcnt(6)
  v_mfma_f32_32x32x16_bf16 v[192:207], v[112:115], v[32:35], v[192:207]
  buffer_load_dwordx4 v[24:27], v15, s[56:59], s10 offen offset:3072 sc1
  buffer_load_dwordx4 v[28:31], v15, s[56:59], s17 offen offset:1024 sc1
  s_waitcnt lgkmcnt(4)
  v_mfma_f32_32x32x16_bf16 v[224:239], v[116:119], v[32:35], v[224:239]
  ds_read_b64_tr_b16 v[128:129], v12 offset:2048
  ds_read_b64_tr_b16 v[130:131], v12 offset:3072
  s_waitcnt vmcnt(12)
  v_mfma_f32_32x32x16_bf16 v[208:223], v[184:187], v[36:39], v[208:223]
  ds_read_b64_tr_b16 v[132:133], v13 offset:2048
  ds_read_b64_tr_b16 v[134:135], v13 offset:3072
  v_mfma_f32_32x32x16_bf16 v[240:255], v[188:191], v[36:39], v[240:255]
  v_lshl_add_u32 v3, v4, 3, v3
  s_lshl_b32 s77, s70, 5
  s_add_u32 s77, s77, 151552
  v_add_u32 v3, s77, v3
  v_lshlrev_b32 v4, 3, v8
  s_waitcnt vmcnt(11) lgkmcnt(6)
  v_mfma_f32_32x32x16_bf16 v[192:207], v[120:123], v[40:43], v[192:207]
  buffer_load_dwordx4 v[32:35], v15, s[56:59], s11 offen offset:0 sc1
  buffer_load_dwordx4 v[36:39], v15, s[56:59], s17 offen offset:2048 sc1
  s_waitcnt lgkmcnt(4)
  v_mfma_f32_32x32x16_bf16 v[224:239], v[124:127], v[40:43], v[224:239]
  ds_read_b64_tr_b16 v[136:137], v10 offset:32768
  ds_read_b64_tr_b16 v[138:139], v10 offset:33792
  s_waitcnt vmcnt(12)
  v_mfma_f32_32x32x16_bf16 v[208:223], v[72:75], v[44:47], v[208:223]
  ds_read_b64_tr_b16 v[140:141], v11 offset:32768
  ds_read_b64_tr_b16 v[142:143], v11 offset:33792
  v_mfma_f32_32x32x16_bf16 v[240:255], v[76:79], v[44:47], v[240:255]
  v_add_u32 v4, 161792, v4
  v_lshlrev_b32 v5, 10, v8
  v_lshl_add_u32 v5, v9, 4, v5
  s_lshl_b32 s76, s39, 16
  s_lshl_b32 s77, s38, 7
  s_waitcnt vmcnt(11) lgkmcnt(6)
  v_mfma_f32_32x32x16_bf16 v[192:207], v[128:131], v[48:51], v[192:207]
  buffer_load_dwordx4 v[40:43], v15, s[56:59], s11 offen offset:1024 sc1
  buffer_load_dwordx4 v[44:47], v15, s[56:59], s17 offen offset:3072 sc1
  s_waitcnt lgkmcnt(4)
  v_mfma_f32_32x32x16_bf16 v[224:239], v[132:135], v[48:51], v[224:239]
  ds_read_b64_tr_b16 v[144:145], v10 offset:34816
  ds_read_b64_tr_b16 v[146:147], v10 offset:35840
  s_waitcnt vmcnt(12)
  v_mfma_f32_32x32x16_bf16 v[208:223], v[80:83], v[52:55], v[208:223]
  ds_read_b64_tr_b16 v[148:149], v11 offset:34816
  ds_read_b64_tr_b16 v[150:151], v11 offset:35840
  v_mfma_f32_32x32x16_bf16 v[240:255], v[84:87], v[52:55], v[240:255]
  s_add_u32 s76, s76, s77
  s_waitcnt vmcnt(11) lgkmcnt(6)
  v_mfma_f32_32x32x16_bf16 v[192:207], v[136:139], v[56:59], v[192:207]
  buffer_load_dwordx4 v[48:51], v15, s[56:59], s18 offen offset:0 sc1
  buffer_load_dwordx4 v[52:55], v15, s[56:59], s18 offen offset:1024 sc1
  s_waitcnt lgkmcnt(4)
  v_mfma_f32_32x32x16_bf16 v[224:239], v[140:143], v[56:59], v[224:239]
  ds_read_b64_tr_b16 v[152:153], v10 offset:49152
  ds_read_b64_tr_b16 v[154:155], v10 offset:50176
  s_waitcnt vmcnt(12)
  v_mfma_f32_32x32x16_bf16 v[208:223], v[88:91], v[60:63], v[208:223]
  ds_read_b64_tr_b16 v[156:157], v11 offset:49152
  ds_read_b64_tr_b16 v[158:159], v11 offset:50176
  v_mfma_f32_32x32x16_bf16 v[240:255], v[92:95], v[60:63], v[240:255]
  s_waitcnt vmcnt(11) lgkmcnt(6)
  v_mfma_f32_32x32x16_bf16 v[192:207], v[144:147], v[64:67], v[192:207]
  buffer_load_dwordx4 v[56:59], v15, s[56:59], s18 offen offset:2048 sc1
  buffer_load_dwordx4 v[60:63], v15, s[56:59], s18 offen offset:3072 sc1
  s_waitcnt lgkmcnt(4)
  v_mfma_f32_32x32x16_bf16 v[224:239], v[148:151], v[64:67], v[224:239]
  ds_read_b64_tr_b16 v[160:161], v10 offset:51200
  ds_read_b64_tr_b16 v[162:163], v10 offset:52224
  s_waitcnt vmcnt(12)
  v_mfma_f32_32x32x16_bf16 v[208:223], v[96:99], v[68:71], v[208:223]
  ds_read_b64_tr_b16 v[164:165], v11 offset:51200
  ds_read_b64_tr_b16 v[166:167], v11 offset:52224
  v_mfma_f32_32x32x16_bf16 v[240:255], v[100:103], v[68:71], v[240:255]
  s_waitcnt vmcnt(11) lgkmcnt(6)
  v_mfma_f32_32x32x16_bf16 v[192:207], v[152:155], v[16:19], v[192:207]
  buffer_load_dwordx4 v[64:67], v15, s[56:59], s19 offen offset:0 sc1
  buffer_load_dwordx4 v[68:71], v15, s[56:59], s19 offen offset:1024 sc1
  s_waitcnt lgkmcnt(4)
  v_mfma_f32_32x32x16_bf16 v[224:239], v[156:159], v[16:19], v[224:239]
  ds_read_b64_tr_b16 v[168:169], v12 offset:16384
  ds_read_b64_tr_b16 v[170:171], v12 offset:17408
  s_waitcnt vmcnt(12)
  v_mfma_f32_32x32x16_bf16 v[208:223], v[104:107], v[20:23], v[208:223]
  ds_read_b64_tr_b16 v[172:173], v13 offset:16384
  ds_read_b64_tr_b16 v[174:175], v13 offset:17408
  v_mfma_f32_32x32x16_bf16 v[240:255], v[108:111], v[20:23], v[240:255]
  s_waitcnt vmcnt(11) lgkmcnt(6)
  v_mfma_f32_32x32x16_bf16 v[192:207], v[160:163], v[24:27], v[192:207]
  ds_read_b64_tr_b16 v[176:177], v12 offset:18432
  ds_read_b64_tr_b16 v[178:179], v12 offset:19456
  s_waitcnt lgkmcnt(6)
  v_mfma_f32_32x32x16_bf16 v[224:239], v[164:167], v[24:27], v[224:239]
  ds_read_b64_tr_b16 v[180:181], v13 offset:18432
  s_waitcnt vmcnt(10)
  v_mfma_f32_32x32x16_bf16 v[208:223], v[112:115], v[28:31], v[208:223]
  ds_read_b64_tr_b16 v[182:183], v13 offset:19456
  v_mfma_f32_32x32x16_bf16 v[240:255], v[116:119], v[28:31], v[240:255]
  s_waitcnt vmcnt(9) lgkmcnt(6)
  v_mfma_f32_32x32x16_bf16 v[192:207], v[168:171], v[32:35], v[192:207]
  s_waitcnt lgkmcnt(4)
  v_mfma_f32_32x32x16_bf16 v[224:239], v[172:175], v[32:35], v[224:239]
  s_waitcnt vmcnt(8)
  v_mfma_f32_32x32x16_bf16 v[208:223], v[120:123], v[36:39], v[208:223]
  v_mfma_f32_32x32x16_bf16 v[240:255], v[124:127], v[36:39], v[240:255]
  s_waitcnt vmcnt(7) lgkmcnt(2)
  v_mfma_f32_32x32x16_bf16 v[192:207], v[176:179], v[40:43], v[192:207]
  s_waitcnt lgkmcnt(0)
  v_mfma_f32_32x32x16_bf16 v[224:239], v[180:183], v[40:43], v[224:239]
  s_waitcnt vmcnt(6)
  v_mfma_f32_32x32x16_bf16 v[208:223], v[128:131], v[44:47], v[208:223]
  v_mfma_f32_32x32x16_bf16 v[240:255], v[132:135], v[44:47], v[240:255]
  s_waitcnt vmcnt(5)
  v_mfma_f32_32x32x16_bf16 v[208:223], v[136:139], v[48:51], v[208:223]
  s_nop 4
  ds_write_b128 v14, v[192:195] offset:0
  v_mfma_f32_32x32x16_bf16 v[240:255], v[140:143], v[48:51], v[240:255]
  ds_write_b128 v14, v[196:199] offset:1024
  s_waitcnt vmcnt(4)
  v_mfma_f32_32x32x16_bf16 v[208:223], v[144:147], v[52:55], v[208:223]
  ds_write_b128 v14, v[200:203] offset:2048
  v_mfma_f32_32x32x16_bf16 v[240:255], v[148:151], v[52:55], v[240:255]
  ds_write_b128 v14, v[204:207] offset:3072
  s_waitcnt vmcnt(3)
  v_mfma_f32_32x32x16_bf16 v[208:223], v[152:155], v[56:59], v[208:223]
  ds_write_b128 v14, v[224:227] offset:32768
  v_mfma_f32_32x32x16_bf16 v[240:255], v[156:159], v[56:59], v[240:255]
  ds_write_b128 v14, v[228:231] offset:33792
  s_waitcnt vmcnt(2)
  v_mfma_f32_32x32x16_bf16 v[208:223], v[160:163], v[60:63], v[208:223]
  ds_write_b128 v14, v[232:235] offset:34816
  v_mfma_f32_32x32x16_bf16 v[240:255], v[164:167], v[60:63], v[240:255]
  ds_write_b128 v14, v[236:239] offset:35840
  s_waitcnt vmcnt(1)
  v_mfma_f32_32x32x16_bf16 v[208:223], v[168:171], v[64:67], v[208:223]
  v_mfma_f32_32x32x16_bf16 v[240:255], v[172:175], v[64:67], v[240:255]
  s_waitcnt vmcnt(0)
  v_mfma_f32_32x32x16_bf16 v[208:223], v[176:179], v[68:71], v[208:223]
  v_mfma_f32_32x32x16_bf16 v[240:255], v[180:183], v[68:71], v[240:255]
  s_nop 10
  ds_write_b128 v14, v[208:211] offset:16384
  ds_write_b128 v14, v[212:215] offset:17408
  ds_write_b128 v14, v[216:219] offset:18432
  ds_write_b128 v14, v[220:223] offset:19456
  ds_write_b128 v14, v[240:243] offset:49152
  ds_write_b128 v14, v[244:247] offset:50176
  ds_write_b128 v14, v[248:251] offset:51200
  ds_write_b128 v14, v[252:255] offset:52224
  s_waitcnt lgkmcnt(0)
  s_barrier
LF:
  ds_read_b128 v[16:19], v2 offset:0
  ds_read_b128 v[20:23], v2 offset:512
  ds_read_b128 v[24:27], v2 offset:4096
  ds_read_b128 v[28:31], v2 offset:4608
  ds_read_b128 v[32:35], v2 offset:8192
  ds_read_b128 v[36:39], v2 offset:8704
  ds_read_b128 v[40:43], v2 offset:12288
  ds_read_b128 v[44:47], v2 offset:12800
  ds_read_b64_tr_b16 v[48:49], v3 offset:0
  ds_read_b64_tr_b16 v[50:51], v3 offset:640
  ds_read_b64 v[52:53], v4
  s_waitcnt lgkmcnt(8)
  v_add_f32 v16, v16, v24
  v_add_f32 v17, v17, v25
  v_add_f32 v18, v18, v26
  v_add_f32 v19, v19, v27
  s_waitcnt lgkmcnt(7)
  v_add_f32 v20, v20, v28
  v_add_f32 v21, v21, v29
  v_add_f32 v22, v22, v30
  v_add_f32 v23, v23, v31
  s_waitcnt lgkmcnt(4)
  v_add_f32 v32, v32, v40
  v_add_f32 v33, v33, v41
  v_add_f32 v34, v34, v42
  v_add_f32 v35, v35, v43
  s_waitcnt lgkmcnt(3)
  v_add_f32 v36, v36, v44
  v_add_f32 v37, v37, v45
  v_add_f32 v38, v38, v46
  v_add_f32 v39, v39, v47
  v_add_f32 v16, v16, v32
  v_add_f32 v17, v17, v33
  v_add_f32 v18, v18, v34
  v_add_f32 v19, v19, v35
  v_add_f32 v20, v20, v36
  v_add_f32 v21, v21, v37
  v_add_f32 v22, v22, v38
  v_add_f32 v23, v23, v39
  s_waitcnt lgkmcnt(2)
  v_lshlrev_b32 v24, 16, v48
  v_and_b32 v25, 0xffff0000, v48
  v_lshlrev_b32 v26, 16, v49
  v_and_b32 v27, 0xffff0000, v49
  s_waitcnt lgkmcnt(1)
  v_lshlrev_b32 v28, 16, v50
  v_and_b32 v29, 0xffff0000, v50
  v_lshlrev_b32 v30, 16, v51
  v_and_b32 v31, 0xffff0000, v51
  s_waitcnt lgkmcnt(0)
  v_mul_f32 v16, v53, v16
  v_mul_f32 v17, v53, v17
  v_mul_f32 v18, v53, v18
  v_mul_f32 v19, v53, v19
  v_mul_f32 v20, v53, v20
  v_mul_f32 v21, v53, v21
  v_mul_f32 v22, v53, v22
  v_mul_f32 v23, v53, v23
  v_fmac_f32 v16, v52, v24
  v_fmac_f32 v17, v52, v25
  v_fmac_f32 v18, v52, v26
  v_fmac_f32 v19, v52, v27
  v_fmac_f32 v20, v52, v28
  v_fmac_f32 v21, v52, v29
  v_fmac_f32 v22, v52, v30
  v_fmac_f32 v23, v52, v31
  v_cvt_pk_bf16_f32 v32, v16, v17
  v_cvt_pk_bf16_f32 v33, v18, v19
  v_cvt_pk_bf16_f32 v34, v20, v21
  v_cvt_pk_bf16_f32 v35, v22, v23
  buffer_store_dwordx4 v[32:35], v5, s[60:63], s76 offen
  s_endpgm
LGaux:
  s_lshl_b32 s78, s34, 12
  v_lshrrev_b32 v16, 3, v1
  v_bfe_u32 v17, v1, 4, 1
  v_lshlrev_b32 v17, 1, v17
  v_and_b32 v18, 7, v1
  v_xor_b32 v17, v17, v18
  v_lshlrev_b32 v17, 4, v17
  v_lshl_add_u32 v21, v16, 10, v17
  s_lshr_b32 s84, s34, 1
  s_and_b32 s86, s34, 1
  s_lshl_b32 s85, s39, 1
  s_add_u32 s85, s85, s84
  s_lshl_b32 s85, s85, 15
  s_lshl_b32 s70, s86, 9
  s_add_u32 s75, s85, s70
  s_mul_i32 s82, s34, 17408
  s_add_u32 m0, s82, 0
  s_add_u32 s70, s75, 0
  buffer_load_dwordx4 v21, s[40:43], s70 offen lds
  s_add_u32 m0, s82, 1088
  s_add_u32 s70, s75, 8192
  buffer_load_dwordx4 v21, s[40:43], s70 offen lds
  s_add_u32 m0, s82, 2176
  s_add_u32 s70, s75, 16384
  buffer_load_dwordx4 v21, s[40:43], s70 offen lds
  s_add_u32 m0, s82, 3264
  s_add_u32 s70, s75, 24576
  buffer_load_dwordx4 v21, s[40:43], s70 offen lds
  s_add_u32 m0, s82, 4352
  s_add_u32 s70, s75, 128
  buffer_load_dwordx4 v21, s[40:43], s70 offen lds
  s_add_u32 m0, s82, 5440
  s_add_u32 s70, s75, 8320
  buffer_load_dwordx4 v21, s[40:43], s70 offen lds
  s_add_u32 m0, s82, 6528
  s_add_u32 s70, s75, 16512
  buffer_load_dwordx4 v21, s[40:43], s70 offen lds
  s_add_u32 m0, s82, 7616
  s_add_u32 s70, s75, 24704
  buffer_load_dwordx4 v21, s[40:43], s70 offen lds
  s_add_u32 m0, s82, 8704
  s_add_u32 s70, s75, 256
  buffer_load_dwordx4 v21, s[40:43], s70 offen lds
  s_add_u32 m0, s82, 9792
  s_add_u32 s70, s75, 8448
  buffer_load_dwordx4 v21, s[40:43], s70 offen lds
  s_add_u32 m0, s82, 10880
  s_add_u32 s70, s75, 16640
  buffer_load_dwordx4 v21, s[40:43], s70 offen lds
  s_add_u32 m0, s82, 11968
  s_add_u32 s70, s75, 24832
  buffer_load_dwordx4 v21, s[40:43], s70 offen lds
  s_add_u32 m0, s82, 13056
  s_add_u32 s70, s75, 384
  buffer_load_dwordx4 v21, s[40:43], s70 offen lds
  s_add_u32 m0, s82, 14144
  s_add_u32 s70, s75, 8576
  buffer_load_dwordx4 v21, s[40:43], s70 offen lds
  s_add_u32 m0, s82, 15232
  s_add_u32 s70, s75, 16768
  buffer_load_dwordx4 v21, s[40:43], s70 offen lds
  s_add_u32 m0, s82, 16320
  s_add_u32 s70, s75, 24960
  buffer_load_dwordx4 v21, s[40:43], s70 offen lds
  s_lshl_b32 s83, s39, 2
  s_add_u32 s83, s83, s34
  s_lshr_b32 s70, s83, 1
  s_lshl_b32 s83, s83, 8
  s_lshl_b32 s70, s70, 8
  s_add_u32 s83, s83, 11550720
  s_add_u32 s70, s70, 11583488
  v_mov_b32 v23, s83
  v_writelane_b32 v23, s70, 1
  v_mov_b32 v20, 0
  s_mov_b64 exec, 3
  buffer_atomic_swap v20, v23, s[56:59], 0 offen sc1
  s_mov_b64 exec, -1
  v_lshrrev_b32 v19, 4, v1
  v_lshlrev_b32 v16, 4, v19
  v_bfe_u32 v17, v1, 2, 2
  v_lshlrev_b32 v17, 7, v17
  v_mul_u32_u24 v18, 1088, v19
  v_add3_u32 v17, v17, v18, s82
  v_and_b32 v18, 3, v1
  v_lshl_add_u32 v17, v18, 3, v17
  v_bfe_u32 v18, v1, 3, 1
  v_lshl_add_u32 v2, v18, 5, v17
  v_xor_b32 v7, 32, v2
  s_add_u32 s71, s78, 69632
  v_and_b32 v18, 15, v1
  v_bfe_u32 v3, v1, 1, 2
  v_xor_b32 v3, v3, v19
  v_lshlrev_b32 v3, 4, v3
  v_lshl_add_u32 v3, v18, 6, v3
  v_add_u32 v3, s71, v3
  v_bfe_u32 v4, v1, 3, 2
  v_xor_b32 v4, v4, v1
  v_lshl_add_u32 v4, v4, 4, s71
  v_bfe_u32 v17, v1, 3, 1
  v_mul_u32_u24 v17, 1088, v17
  v_and_b32 v18, 7, v1
  v_lshl_add_u32 v17, v18, 7, v17
  v_and_b32 v18, 2, v1
  v_lshlrev_b32 v18, 4, v18
  v_xor_b32 v18, v18, v16
  s_mul_i32 s70, s84, 34816
  s_mul_i32 s71, s86, 2176
  s_add_u32 s70, s70, s71
  v_add3_u32 v5, v17, v18, s70
  s_lshl_b32 s70, s86, 14
  s_add_u32 s85, s85, s70
  v_lshrrev_b32 v17, 3, v1
  v_and_b32 v18, 7, v1
  v_lshlrev_b32 v18, 7, v18
  v_lshl_add_u32 v6, v17, 10, v18
  s_lshl_b32 s87, s34, 6
  s_add_u32 s87, s87, s39
  s_mul_i32 s87, s87, 7168
  v_mov_b32 v22, v16
  v_lshlrev_b32 v15, 4, v1
  v_lshrrev_b32 v16, 5, v1
  v_bfe_u32 v17, v1, 2, 2
  v_lshl_add_u32 v16, v16, 2, v17
  v_lshlrev_b32 v16, 7, v16
  v_and_b32 v18, 3, v1
  v_lshl_add_u32 v16, v18, 3, v16
  v_bfe_u32 v18, v1, 4, 1
  v_lshl_add_u32 v16, v18, 5, v16
  v_bfe_u32 v18, v1, 3, 1
  v_lshl_add_u32 v16, v18, 6, v16
  v_add_u32 v10, s78, v16
  v_xor_b32 v11, 64, v10
  v_add_u32 v12, 0x10000, v10
  v_add_u32 v13, 0x10000, v11
  v_lshrrev_b32 v16, 3, v1
  v_and_b32 v17, 7, v1
  v_bfe_u32 v18, v1, 4, 1
  v_lshlrev_b32 v18, 2, v18
  v_xor_b32 v17, v17, v18
  v_lshlrev_b32 v17, 4, v17
  v_lshl_add_u32 v16, v16, 10, v17
  s_lshl_b32 s70, s38, 7
  v_add_u32 v14, s70, v16
  s_mul_i32 s70, s34, 458752
  s_mov_b32 s79, s37
  s_and_b32 s79, s79, 1
  s_mul_i32 s71, s79, 229376
  s_add_u32 s76, s70, s71
  s_sub_u32 s77, s70, s71
  s_add_u32 s77, s77, 229376
  s_waitcnt vmcnt(13)
  ds_read_b64_tr_b16 v[64:65], v2 offset:0
  ds_read_b64_tr_b16 v[66:67], v2 offset:512
  ds_read_b64_tr_b16 v[68:69], v7 offset:0
  ds_read_b64_tr_b16 v[70:71], v7 offset:512
  ds_read_b64_tr_b16 v[72:73], v2 offset:64
  ds_read_b64_tr_b16 v[74:75], v2 offset:576
  ds_read_b64_tr_b16 v[76:77], v7 offset:64
  ds_read_b64_tr_b16 v[78:79], v7 offset:576
  s_waitcnt lgkmcnt(6)
  ds_write_b128 v3, v[64:67] offset:0
  ds_read_b128 v[192:195], v4 offset:0
  s_waitcnt lgkmcnt(6)
  ds_write_b128 v3, v[68:71] offset:1024
  ds_read_b128 v[196:199], v4 offset:1024
  s_waitcnt lgkmcnt(6)
  ds_write_b128 v3, v[72:75] offset:2048
  ds_read_b128 v[200:203], v4 offset:2048
  s_waitcnt lgkmcnt(6)
  ds_write_b128 v3, v[76:79] offset:3072
  ds_read_b128 v[204:207], v4 offset:3072
  s_add_u32 s70, s85, 0
  s_waitcnt lgkmcnt(6)
  buffer_store_dwordx4 v[192:195], v15, s[56:59], s70 offen offset:0 sc1
  s_waitcnt lgkmcnt(4)
  buffer_store_dwordx4 v[196:199], v15, s[56:59], s70 offen offset:1024 sc1
  s_waitcnt lgkmcnt(2)
  buffer_store_dwordx4 v[200:203], v15, s[56:59], s70 offen offset:2048 sc1
  s_waitcnt lgkmcnt(0)
  buffer_store_dwordx4 v[204:207], v15, s[56:59], s70 offen offset:3072 sc1
  s_waitcnt vmcnt(13)
  ds_read_b64_tr_b16 v[80:81], v2 offset:4352
  ds_read_b64_tr_b16 v[82:83], v2 offset:4864
  ds_read_b64_tr_b16 v[84:85], v7 offset:4352
  ds_read_b64_tr_b16 v[86:87], v7 offset:4864
  ds_read_b64_tr_b16 v[88:89], v2 offset:4416
  ds_read_b64_tr_b16 v[90:91], v2 offset:4928
  ds_read_b64_tr_b16 v[92:93], v7 offset:4416
  ds_read_b64_tr_b16 v[94:95], v7 offset:4928
  s_waitcnt lgkmcnt(6)
  ds_write_b128 v3, v[80:83] offset:0
  ds_read_b128 v[208:211], v4 offset:0
  s_waitcnt lgkmcnt(6)
  ds_write_b128 v3, v[84:87] offset:1024
  ds_read_b128 v[212:215], v4 offset:1024
  s_waitcnt lgkmcnt(6)
  ds_write_b128 v3, v[88:91] offset:2048
  ds_read_b128 v[216:219], v4 offset:2048
  s_waitcnt lgkmcnt(6)
  ds_write_b128 v3, v[92:95] offset:3072
  ds_read_b128 v[220:223], v4 offset:3072
  s_add_u32 s70, s85, 4096
  s_waitcnt lgkmcnt(6)
  buffer_store_dwordx4 v[208:211], v15, s[56:59], s70 offen offset:0 sc1
  s_waitcnt lgkmcnt(4)
  buffer_store_dwordx4 v[212:215], v15, s[56:59], s70 offen offset:1024 sc1
  s_waitcnt lgkmcnt(2)
  buffer_store_dwordx4 v[216:219], v15, s[56:59], s70 offen offset:2048 sc1
  s_waitcnt lgkmcnt(0)
  buffer_store_dwordx4 v[220:223], v15, s[56:59], s70 offen offset:3072 sc1
  s_waitcnt vmcnt(13)
  ds_read_b64_tr_b16 v[96:97], v2 offset:8704
  ds_read_b64_tr_b16 v[98:99], v2 offset:9216
  ds_read_b64_tr_b16 v[100:101], v7 offset:8704
  ds_read_b64_tr_b16 v[102:103], v7 offset:9216
  ds_read_b64_tr_b16 v[104:105], v2 offset:8768
  ds_read_b64_tr_b16 v[106:107], v2 offset:9280
  ds_read_b64_tr_b16 v[108:109], v7 offset:8768
  ds_read_b64_tr_b16 v[110:111], v7 offset:9280
  s_waitcnt lgkmcnt(6)
  ds_write_b128 v3, v[96:99] offset:0
  ds_read_b128 v[224:227], v4 offset:0
  s_waitcnt lgkmcnt(6)
  ds_write_b128 v3, v[100:103] offset:1024
  ds_read_b128 v[228:231], v4 offset:1024
  s_waitcnt lgkmcnt(6)
  ds_write_b128 v3, v[104:107] offset:2048
  ds_read_b128 v[232:235], v4 offset:2048
  s_waitcnt lgkmcnt(6)
  ds_write_b128 v3, v[108:111] offset:3072
  ds_read_b128 v[236:239], v4 offset:3072
  s_add_u32 s70, s85, 8192
  s_waitcnt lgkmcnt(6)
  buffer_store_dwordx4 v[224:227], v15, s[56:59], s70 offen offset:0 sc1
  s_waitcnt lgkmcnt(4)
  buffer_store_dwordx4 v[228:231], v15, s[56:59], s70 offen offset:1024 sc1
  s_waitcnt lgkmcnt(2)
  buffer_store_dwordx4 v[232:235], v15, s[56:59], s70 offen offset:2048 sc1
  s_waitcnt lgkmcnt(0)
  buffer_store_dwordx4 v[236:239], v15, s[56:59], s70 offen offset:3072 sc1
  s_waitcnt vmcnt(13)
  ds_read_b64_tr_b16 v[112:113], v2 offset:13056
  ds_read_b64_tr_b16 v[114:115], v2 offset:13568
  ds_read_b64_tr_b16 v[116:117], v7 offset:13056
  ds_read_b64_tr_b16 v[118:119], v7 offset:13568
  ds_read_b64_tr_b16 v[120:121], v2 offset:13120
  ds_read_b64_tr_b16 v[122:123], v2 offset:13632
  ds_read_b64_tr_b16 v[124:125], v7 offset:13120
  ds_read_b64_tr_b16 v[126:127], v7 offset:13632
  global_load_dwordx4 v[128:131], v22, s[26:27] offset:0
  global_load_dwordx4 v[132:135], v22, s[26:27] offset:64
  global_load_dwordx4 v[136:139], v22, s[26:27] offset:128
  global_load_dwordx4 v[140:143], v22, s[26:27] offset:192
  global_load_dwordx4 v[144:147], v22, s[26:27] offset:256
  global_load_dwordx4 v[148:151], v22, s[26:27] offset:320
  global_load_dwordx4 v[152:155], v22, s[26:27] offset:384
  global_load_dwordx4 v[156:159], v22, s[26:27] offset:448
  global_load_dwordx4 v[160:163], v22, s[26:27] offset:512
  global_load_dwordx4 v[164:167], v22, s[26:27] offset:576
  global_load_dwordx4 v[168:171], v22, s[26:27] offset:640
  global_load_dwordx4 v[172:175], v22, s[26:27] offset:704
  global_load_dwordx4 v[176:179], v22, s[26:27] offset:768
  global_load_dwordx4 v[180:183], v22, s[26:27] offset:832
  global_load_dwordx4 v[184:187], v22, s[26:27] offset:896
  global_load_dwordx4 v[188:191], v22, s[26:27] offset:960
  s_waitcnt lgkmcnt(6)
  ds_write_b128 v3, v[112:115] offset:0
  ds_read_b128 v[240:243], v4 offset:0
  s_waitcnt lgkmcnt(6)
  ds_write_b128 v3, v[116:119] offset:1024
  ds_read_b128 v[244:247], v4 offset:1024
  s_waitcnt lgkmcnt(6)
  ds_write_b128 v3, v[120:123] offset:2048
  ds_read_b128 v[248:251], v4 offset:2048
  s_waitcnt lgkmcnt(6)
  ds_write_b128 v3, v[124:127] offset:3072
  ds_read_b128 v[252:255], v4 offset:3072
  s_add_u32 s70, s85, 12288
  s_waitcnt lgkmcnt(6)
  buffer_store_dwordx4 v[240:243], v15, s[56:59], s70 offen offset:0 sc1
  s_waitcnt lgkmcnt(4)
  buffer_store_dwordx4 v[244:247], v15, s[56:59], s70 offen offset:1024 sc1
  s_waitcnt lgkmcnt(2)
  buffer_store_dwordx4 v[248:251], v15, s[56:59], s70 offen offset:2048 sc1
  s_waitcnt lgkmcnt(0)
  buffer_store_dwordx4 v[252:255], v15, s[56:59], s70 offen offset:3072 sc1
  s_barrier
  ds_read_b128 v[64:67], v5 offset:0
  ds_read_b128 v[68:71], v5 offset:64
  ds_read_b128 v[72:75], v5 offset:4352
  ds_read_b128 v[76:79], v5 offset:4416
  ds_read_b128 v[80:83], v5 offset:8704
  ds_read_b128 v[84:87], v5 offset:8768
  ds_read_b128 v[88:91], v5 offset:13056
  ds_read_b128 v[92:95], v5 offset:13120
  ds_read_b128 v[96:99], v5 offset:17408
  ds_read_b128 v[100:103], v5 offset:17472
  ds_read_b128 v[104:107], v5 offset:21760
  ds_read_b128 v[108:111], v5 offset:21824
  ds_read_b128 v[112:115], v5 offset:26112
  ds_read_b128 v[116:119], v5 offset:26176
  ds_read_b128 v[120:123], v5 offset:30464
  ds_read_b128 v[124:127], v5 offset:30528
  v_mov_b32 v23, 1
  v_mov_b32 v20, 1
  s_waitcnt vmcnt(0)
  s_mov_b64 exec, 1
  buffer_atomic_add v23, off, s[64:67], 0 offset:0 sc0 sc1
  s_mov_b64 exec, -1
  s_waitcnt lgkmcnt(15)
  v_mfma_f32_16x16x32_bf16 v[24:27], v[64:67], v[128:131], 0
  s_waitcnt lgkmcnt(14)
  v_mfma_f32_16x16x32_bf16 v[24:27], v[68:71], v[132:135], v[24:27]
  s_waitcnt lgkmcnt(13)
  v_mfma_f32_16x16x32_bf16 v[24:27], v[72:75], v[136:139], v[24:27]
  s_waitcnt lgkmcnt(12)
  v_mfma_f32_16x16x32_bf16 v[24:27], v[76:79], v[140:143], v[24:27]
  s_waitcnt lgkmcnt(11)
  v_mfma_f32_16x16x32_bf16 v[24:27], v[80:83], v[144:147], v[24:27]
  s_waitcnt lgkmcnt(10)
  v_mfma_f32_16x16x32_bf16 v[24:27], v[84:87], v[148:151], v[24:27]
  s_waitcnt lgkmcnt(9)
  v_mfma_f32_16x16x32_bf16 v[24:27], v[88:91], v[152:155], v[24:27]
  s_waitcnt lgkmcnt(8)
  v_mfma_f32_16x16x32_bf16 v[24:27], v[92:95], v[156:159], v[24:27]
  s_waitcnt lgkmcnt(7)
  v_mfma_f32_16x16x32_bf16 v[24:27], v[96:99], v[160:163], v[24:27]
  s_waitcnt lgkmcnt(6)
  v_mfma_f32_16x16x32_bf16 v[24:27], v[100:103], v[164:167], v[24:27]
  s_waitcnt lgkmcnt(5)
  v_mfma_f32_16x16x32_bf16 v[24:27], v[104:107], v[168:171], v[24:27]
  s_waitcnt lgkmcnt(4)
  v_mfma_f32_16x16x32_bf16 v[24:27], v[108:111], v[172:175], v[24:27]
  s_waitcnt lgkmcnt(3)
  v_mfma_f32_16x16x32_bf16 v[24:27], v[112:115], v[176:179], v[24:27]
  s_waitcnt lgkmcnt(2)
  v_mfma_f32_16x16x32_bf16 v[24:27], v[116:119], v[180:183], v[24:27]
  s_waitcnt lgkmcnt(1)
  v_mfma_f32_16x16x32_bf16 v[24:27], v[120:123], v[184:187], v[24:27]
  s_waitcnt lgkmcnt(0)
  v_mfma_f32_16x16x32_bf16 v[24:27], v[124:127], v[188:191], v[24:27]
  s_nop 7
  v_cvt_pk_bf16_f32 v24, v24, v24
  v_and_b32 v24, 0xffff0000, v24
  v_cvt_pk_bf16_f32 v25, v25, v25
  v_and_b32 v25, 0xffff0000, v25
  v_cvt_pk_bf16_f32 v26, v26, v26
  v_and_b32 v26, 0xffff0000, v26
  v_cvt_pk_bf16_f32 v27, v27, v27
  v_and_b32 v27, 0xffff0000, v27
  v_mul_f32 v24, 0xbfb8aa3b, v24
  v_mul_f32 v25, 0xbfb8aa3b, v25
  v_mul_f32 v26, 0xbfb8aa3b, v26
  v_mul_f32 v27, 0xbfb8aa3b, v27
  v_exp_f32 v24, v24
  v_exp_f32 v25, v25
  v_exp_f32 v26, v26
  v_exp_f32 v27, v27
  v_add_f32 v24, 1.0, v24
  v_add_f32 v25, 1.0, v25
  v_add_f32 v26, 1.0, v26
  v_add_f32 v27, 1.0, v27
  v_rcp_f32 v24, v24
  v_rcp_f32 v25, v25
  v_rcp_f32 v26, v26
  v_rcp_f32 v27, v27
  v_cvt_pk_bf16_f32 v28, v24, v24
  v_and_b32 v28, 0xffff0000, v28
  v_cvt_pk_bf16_f32 v30, v25, v25
  v_and_b32 v30, 0xffff0000, v30
  v_cvt_pk_bf16_f32 v32, v26, v26
  v_and_b32 v32, 0xffff0000, v32
  v_cvt_pk_bf16_f32 v34, v27, v27
  v_and_b32 v34, 0xffff0000, v34
  v_sub_f32 v24, 1.0, v28
  v_sub_f32 v25, 1.0, v30
  v_sub_f32 v26, 1.0, v32
  v_sub_f32 v27, 1.0, v34
  v_cvt_pk_bf16_f32 v29, v24, v24
  v_and_b32 v29, 0xffff0000, v29
  v_cvt_pk_bf16_f32 v31, v25, v25
  v_and_b32 v31, 0xffff0000, v31
  v_cvt_pk_bf16_f32 v33, v26, v26
  v_and_b32 v33, 0xffff0000, v33
  v_cvt_pk_bf16_f32 v35, v27, v27
  v_and_b32 v35, 0xffff0000, v35
  v_lshrrev_b32 v19, 4, v1
  v_lshlrev_b32 v16, 5, v19
  s_lshl_b32 s70, s39, 9
  s_lshl_b32 s71, s34, 7
  s_add_u32 s70, s70, s71
  s_add_u32 s70, s70, 11534336
  s_waitcnt vmcnt(0)
  v_readfirstlane_b32 s81, v23
  s_cmp_lg_u32 s81, 127
  s_cbranch_scc1 Ln3
  s_mov_b64 exec, 1
  buffer_store_dword v20, off, s[64:67], 0 offset:128 sc1
  s_mov_b64 exec, -1
Ln3:
  s_mov_b32 exec_lo, 0x10001
  s_mov_b32 exec_hi, 0x10001
  buffer_store_dwordx4 v[28:31], v16, s[56:59], s70 offen offset:0 sc1
  buffer_store_dwordx4 v[32:35], v16, s[56:59], s70 offen offset:16 sc1
  s_mov_b64 exec, -1
  s_barrier
  s_add_u32 m0, s78, 98304
  s_add_u32 s70, s76, 0
  buffer_load_dwordx4 v14, s[52:55], s70 offen lds
  s_add_u32 m0, s78, 99328
  s_add_u32 s70, s76, 8192
  buffer_load_dwordx4 v14, s[52:55], s70 offen lds
  s_add_u32 m0, s78, 100352
  s_add_u32 s70, s76, 16384
  buffer_load_dwordx4 v14, s[52:55], s70 offen lds
  s_add_u32 m0, s78, 101376
  s_add_u32 s70, s76, 24576
  buffer_load_dwordx4 v14, s[52:55], s70 offen lds
  s_add_u32 m0, s78, 0
  s_add_u32 s70, s76, 32768
  buffer_load_dwordx4 v14, s[52:55], s70 offen lds
  s_add_u32 m0, s78, 1024
  s_add_u32 s70, s76, 40960
  buffer_load_dwordx4 v14, s[52:55], s70 offen lds
  s_add_u32 m0, s78, 2048
  s_add_u32 s70, s76, 49152
  buffer_load_dwordx4 v14, s[52:55], s70 offen lds
  s_add_u32 m0, s78, 3072
  s_add_u32 s70, s76, 57344
  buffer_load_dwordx4 v14, s[52:55], s70 offen lds
  s_add_u32 m0, s78, 16384
  s_add_u32 s70, s76, 65536
  buffer_load_dwordx4 v14, s[52:55], s70 offen lds
  s_add_u32 m0, s78, 17408
  s_add_u32 s70, s76, 73728
  buffer_load_dwordx4 v14, s[52:55], s70 offen lds
  s_add_u32 m0, s78, 18432
  s_add_u32 s70, s76, 81920
  buffer_load_dwordx4 v14, s[52:55], s70 offen lds
  s_add_u32 m0, s78, 19456
  s_add_u32 s70, s76, 90112
  buffer_load_dwordx4 v14, s[52:55], s70 offen lds
  s_add_u32 m0, s78, 65536
  s_add_u32 s70, s76, 98304
  buffer_load_dwordx4 v14, s[52:55], s70 offen lds
  s_add_u32 m0, s78, 66560
  s_add_u32 s70, s76, 106496
  buffer_load_dwordx4 v14, s[52:55], s70 offen lds
  s_add_u32 m0, s78, 67584
  s_add_u32 s70, s76, 114688
  buffer_load_dwordx4 v14, s[52:55], s70 offen lds
  s_add_u32 m0, s78, 68608
  s_add_u32 s70, s76, 122880
  buffer_load_dwordx4 v14, s[52:55], s70 offen lds
  s_add_u32 m0, s78, 32768
  s_add_u32 s70, s76, 131072
  buffer_load_dwordx4 v14, s[52:55], s70 offen lds
  s_add_u32 m0, s78, 33792
  s_add_u32 s70, s76, 139264
  buffer_load_dwordx4 v14, s[52:55], s70 offen lds
  s_add_u32 m0, s78, 34816
  s_add_u32 s70, s76, 147456
  buffer_load_dwordx4 v14, s[52:55], s70 offen lds
  s_add_u32 m0, s78, 35840
  s_add_u32 s70, s76, 155648
  buffer_load_dwordx4 v14, s[52:55], s70 offen lds
  s_add_u32 m0, s78, 49152
  s_add_u32 s70, s76, 163840
  buffer_load_dwordx4 v14, s[52:55], s70 offen lds
  s_add_u32 m0, s78, 50176
  s_add_u32 s70, s76, 172032
  buffer_load_dwordx4 v14, s[52:55], s70 offen lds
  s_add_u32 m0, s78, 51200
  s_add_u32 s70, s76, 180224
  buffer_load_dwordx4 v14, s[52:55], s70 offen lds
  s_add_u32 m0, s78, 52224
  s_add_u32 s70, s76, 188416
  buffer_load_dwordx4 v14, s[52:55], s70 offen lds
  s_add_u32 m0, s78, 81920
  s_add_u32 s70, s76, 196608
  buffer_load_dwordx4 v14, s[52:55], s70 offen lds
  s_add_u32 m0, s78, 82944
  s_add_u32 s70, s76, 204800
  buffer_load_dwordx4 v14, s[52:55], s70 offen lds
  s_add_u32 m0, s78, 83968
  s_add_u32 s70, s76, 212992
  buffer_load_dwordx4 v14, s[52:55], s70 offen lds
  s_add_u32 m0, s78, 84992
  s_add_u32 s70, s76, 221184
  buffer_load_dwordx4 v14, s[52:55], s70 offen lds
  s_waitcnt vmcnt(0)
  v_mov_b32 v16, 163776
  s_mov_b32 s69, 131072
Lp4:
  ds_read_b32 v17, v16
  s_waitcnt lgkmcnt(0)
  v_cmp_eq_u32 vcc, 0, v17
  s_cbranch_vccz Lk5
  s_sub_u32 s69, s69, 1
  s_cbranch_scc0 Lp4
Lk5:
  s_nop 0
  s_nop 0
  s_mov_b64 exec, 1
  buffer_atomic_add v20, off, s[56:59], s83 sc1
  s_mov_b64 exec, -1
  ds_read_b64_tr_b16 v[80:81], v12 offset:32768
  ds_read_b64_tr_b16 v[82:83], v12 offset:33792
  ds_read_b64_tr_b16 v[84:85], v13 offset:32768
  ds_read_b64_tr_b16 v[86:87], v13 offset:33792
  ds_read_b64_tr_b16 v[88:89], v12 offset:34816
  ds_read_b64_tr_b16 v[90:91], v12 offset:35840
  ds_read_b64_tr_b16 v[92:93], v13 offset:34816
  ds_read_b64_tr_b16 v[94:95], v13 offset:35840
  ds_read_b64_tr_b16 v[96:97], v10 offset:0
  ds_read_b64_tr_b16 v[98:99], v10 offset:1024
  ds_read_b64_tr_b16 v[100:101], v11 offset:0
  ds_read_b64_tr_b16 v[102:103], v11 offset:1024
  ds_read_b64_tr_b16 v[104:105], v10 offset:2048
  ds_read_b64_tr_b16 v[106:107], v10 offset:3072
  ds_read_b64_tr_b16 v[108:109], v11 offset:2048
  ds_read_b64_tr_b16 v[110:111], v11 offset:3072
  ds_read_b64_tr_b16 v[112:113], v10 offset:16384
  ds_read_b64_tr_b16 v[114:115], v10 offset:17408
  ds_read_b64_tr_b16 v[116:117], v11 offset:16384
  ds_read_b64_tr_b16 v[118:119], v11 offset:17408
  ds_read_b64_tr_b16 v[120:121], v10 offset:18432
  ds_read_b64_tr_b16 v[122:123], v10 offset:19456
  ds_read_b64_tr_b16 v[124:125], v11 offset:18432
  ds_read_b64_tr_b16 v[126:127], v11 offset:19456
  ds_read_b64_tr_b16 v[128:129], v12 offset:0
  ds_read_b64_tr_b16 v[130:131], v12 offset:1024
  ds_read_b64_tr_b16 v[132:133], v13 offset:0
  ds_read_b64_tr_b16 v[134:135], v13 offset:1024
  ds_read_b64_tr_b16 v[136:137], v12 offset:2048
  ds_read_b64_tr_b16 v[138:139], v12 offset:3072
  ds_read_b64_tr_b16 v[140:141], v13 offset:2048
  ds_read_b64_tr_b16 v[142:143], v13 offset:3072
  ds_read_b64_tr_b16 v[144:145], v10 offset:32768
  ds_read_b64_tr_b16 v[146:147], v10 offset:33792
  ds_read_b64_tr_b16 v[148:149], v11 offset:32768
  ds_read_b64_tr_b16 v[150:151], v11 offset:33792
  ds_read_b64_tr_b16 v[152:153], v10 offset:34816
  ds_read_b64_tr_b16 v[154:155], v10 offset:35840
  ds_read_b64_tr_b16 v[156:157], v11 offset:34816
  ds_read_b64_tr_b16 v[158:159], v11 offset:35840
  ds_read_b64_tr_b16 v[160:161], v10 offset:49152
  ds_read_b64_tr_b16 v[162:163], v10 offset:50176
  ds_read_b64_tr_b16 v[164:165], v11 offset:49152
  ds_read_b64_tr_b16 v[166:167], v11 offset:50176
  ds_read_b64_tr_b16 v[168:169], v10 offset:51200
  ds_read_b64_tr_b16 v[170:171], v10 offset:52224
  ds_read_b64_tr_b16 v[172:173], v11 offset:51200
  ds_read_b64_tr_b16 v[174:175], v11 offset:52224
  ds_read_b64_tr_b16 v[176:177], v12 offset:16384
  ds_read_b64_tr_b16 v[178:179], v12 offset:17408
  ds_read_b64_tr_b16 v[180:181], v13 offset:16384
  ds_read_b64_tr_b16 v[182:183], v13 offset:17408
  ds_read_b64_tr_b16 v[184:185], v12 offset:18432
  ds_read_b64_tr_b16 v[186:187], v12 offset:19456
  ds_read_b64_tr_b16 v[188:189], v13 offset:18432
  ds_read_b64_tr_b16 v[190:191], v13 offset:19456
  s_waitcnt lgkmcnt(0)
  s_add_u32 m0, s78, 98304
  s_add_u32 s70, s77, 0
  buffer_load_dwordx4 v14, s[52:55], s70 offen lds
  s_add_u32 m0, s78, 99328
  s_add_u32 s70, s77, 8192
  buffer_load_dwordx4 v14, s[52:55], s70 offen lds
  s_add_u32 m0, s78, 100352
  s_add_u32 s70, s77, 16384
  buffer_load_dwordx4 v14, s[52:55], s70 offen lds
  s_add_u32 m0, s78, 101376
  s_add_u32 s70, s77, 24576
  buffer_load_dwordx4 v14, s[52:55], s70 offen lds
  s_add_u32 m0, s78, 0
  s_add_u32 s70, s77, 32768
  buffer_load_dwordx4 v14, s[52:55], s70 offen lds
  s_add_u32 m0, s78, 1024
  s_add_u32 s70, s77, 40960
  buffer_load_dwordx4 v14, s[52:55], s70 offen lds
  s_add_u32 m0, s78, 2048
  s_add_u32 s70, s77, 49152
  buffer_load_dwordx4 v14, s[52:55], s70 offen lds
  s_add_u32 m0, s78, 3072
  s_add_u32 s70, s77, 57344
  buffer_load_dwordx4 v14, s[52:55], s70 offen lds
  s_add_u32 m0, s78, 16384
  s_add_u32 s70, s77, 65536
  buffer_load_dwordx4 v14, s[52:55], s70 offen lds
  s_add_u32 m0, s78, 17408
  s_add_u32 s70, s77, 73728
  buffer_load_dwordx4 v14, s[52:55], s70 offen lds
  s_add_u32 m0, s78, 18432
  s_add_u32 s70, s77, 81920
  buffer_load_dwordx4 v14, s[52:55], s70 offen lds
  s_add_u32 m0, s78, 19456
  s_add_u32 s70, s77, 90112
  buffer_load_dwordx4 v14, s[52:55], s70 offen lds
  s_add_u32 m0, s78, 65536
  s_add_u32 s70, s77, 98304
  buffer_load_dwordx4 v14, s[52:55], s70 offen lds
  s_add_u32 m0, s78, 66560
  s_add_u32 s70, s77, 106496
  buffer_load_dwordx4 v14, s[52:55], s70 offen lds
  s_add_u32 m0, s78, 67584
  s_add_u32 s70, s77, 114688
  buffer_load_dwordx4 v14, s[52:55], s70 offen lds
  s_add_u32 m0, s78, 68608
  s_add_u32 s70, s77, 122880
  buffer_load_dwordx4 v14, s[52:55], s70 offen lds
  s_add_u32 m0, s78, 32768
  s_add_u32 s70, s77, 131072
  buffer_load_dwordx4 v14, s[52:55], s70 offen lds
  s_add_u32 m0, s78, 33792
  s_add_u32 s70, s77, 139264
  buffer_load_dwordx4 v14, s[52:55], s70 offen lds
  s_add_u32 m0, s78, 34816
  s_add_u32 s70, s77, 147456
  buffer_load_dwordx4 v14, s[52:55], s70 offen lds
  s_add_u32 m0, s78, 35840
  s_add_u32 s70, s77, 155648
  buffer_load_dwordx4 v14, s[52:55], s70 offen lds
  s_add_u32 m0, s78, 49152
  s_add_u32 s70, s77, 163840
  buffer_load_dwordx4 v14, s[52:55], s70 offen lds
  s_add_u32 m0, s78, 50176
  s_add_u32 s70, s77, 172032
  buffer_load_dwordx4 v14, s[52:55], s70 offen lds
  s_add_u32 m0, s78, 51200
  s_add_u32 s70, s77, 180224
  buffer_load_dwordx4 v14, s[52:55], s70 offen lds
  s_add_u32 m0, s78, 52224
  s_add_u32 s70, s77, 188416
  buffer_load_dwordx4 v14, s[52:55], s70 offen lds
  s_add_u32 m0, s78, 81920
  s_add_u32 s70, s77, 196608
  buffer_load_dwordx4 v14, s[52:55], s70 offen lds
  s_add_u32 m0, s78, 82944
  s_add_u32 s70, s77, 204800
  buffer_load_dwordx4 v14, s[52:55], s70 offen lds
  s_add_u32 m0, s78, 83968
  s_add_u32 s70, s77, 212992
  buffer_load_dwordx4 v14, s[52:55], s70 offen lds
  s_add_u32 m0, s78, 84992
  s_add_u32 s70, s77, 221184
  buffer_load_dwordx4 v14, s[52:55], s70 offen lds
  s_mul_i32 s70, s39, 224
  s_mul_i32 s71, s34, 28
  s_add_u32 s70, s70, s71
  s_mul_i32 s71, s79, 14
  s_add_u32 s4, s70, s71
  s_sub_u32 s8, s70, s71
  s_add_u32 s8, s8, 14
  s_lshl_b32 s4, s4, 10
  s_add_u32 s4, s4, 2097152
  s_lshl_b32 s8, s8, 10
  s_add_u32 s8, s8, 2097152
  s_add_u32 s5, s4, 4096
  s_add_u32 s6, s4, 8192
  s_add_u32 s7, s4, 12288
  s_add_u32 s12, s4, 114688
  s_add_u32 s13, s4, 118784
  s_add_u32 s14, s4, 122880
  s_add_u32 s15, s4, 126976
  s_add_u32 s9, s8, 4096
  s_add_u32 s10, s8, 8192
  s_add_u32 s11, s8, 12288
  s_add_u32 s16, s8, 114688
  s_add_u32 s17, s8, 118784
  s_add_u32 s18, s8, 122880
  s_add_u32 s19, s8, 126976
  s_lshl_b32 s87, s39, 2
  s_add_u32 s87, s87, s34
  s_lshl_b32 s86, s87, 7
  s_add_u32 s86, s86, 11534336
  s_lshl_b32 s87, s87, 8
  s_add_u32 s87, s87, 11550720
  v_and_b32 v8, 15, v1
  v_lshlrev_b32 v8, 3, v8
  v_mov_b32 v17, 8
  s_mov_b64 exec, 1
  v_mov_b32 v17, 0
  buffer_atomic_or v17, off, s[56:59], s87 sc0 sc1
  s_mov_b64 exec, -1
  s_waitcnt vmcnt(0)
  s_branch LG2
LA:
  s_setprio 1
  s_sub_u32 s75, s34, 4
  s_lshr_b32 s76, s75, 1
  s_and_b32 s77, s75, 1
  s_and_b32 s87, s2, 31
  s_lshl_b32 s70, s38, 5
  s_add_u32 s87, s87, s70
  s_lshl_b32 s79, s87, 1
  s_add_u32 s79, s79, s76
  s_mul_i32 s80, s76, 17728
  s_add_u32 s80, s80, 114688
  s_lshl_b32 s70, s87, 2
  s_load_dword s81, s[14:15], s70
  s_load_dword s78, s[16:17], s70
  s_lshl_b32 s70, s79, 8
  s_lshl_b32 s71, s77, 7
  s_add_u32 s70, s70, s71
  v_lshl_add_u32 v20, v1, 1, s70
  global_load_ushort v16, v20, s[6:7]
  global_load_ushort v17, v20, s[8:9]
  global_load_ushort v18, v20, s[10:11]
  global_load_ushort v19, v20, s[12:13]
  s_getpc_b64 s[82:83]
Lpc2777:
  s_lshl_b32 s70, s75, 13
  v_lshl_add_u32 v26, v1, 7, s70
  s_sub_u32 s82, s82, Lpc2777-gated_mix__ssm_conv_s4d__glu_gated_reglu__prompt_kernel
  s_subb_u32 s83, s83, 0
  v_min_u32 v27, Lend-gated_mix__ssm_conv_s4d__glu_gated_reglu__prompt_kernel, v26
  global_load_dword v220, v27, s[82:83]
  v_add_u32 v26, 0x8000, v26
  v_min_u32 v27, Lend-gated_mix__ssm_conv_s4d__glu_gated_reglu__prompt_kernel, v26
  global_load_dword v221, v27, s[82:83]
  v_mov_b32 v28, 0
  v_mov_b32 v29, 0
  v_mov_b32 v30, 0
  v_mov_b32 v31, 0
  v_mov_b32 v26, 151552
  ds_write_b128 v26, v[28:31] offset:0
  ds_write_b128 v26, v[28:31] offset:16
  ds_write_b128 v26, v[28:31] offset:12160
  ds_write_b128 v26, v[28:31] offset:12176
  ds_write_b128 v26, v[28:31] offset:12192
  ds_write_b128 v26, v[28:31] offset:12224
  s_cmp_ge_u32 s36, 28
  s_cbranch_scc1 LAaux
  s_lshl_b32 s70, s75, 9
  s_sub_u32 s70, 2047, s70
  v_lshlrev_b32 v104, 3, v1
  v_sub_u32 v104, s70, v104
  v_cvt_f32_u32 v105, v104
  s_mov_b32 s82, 151584
  s_movk_i32 s83, 128
  v_add_f32 v106, 0x80000000, v105
  v_add_f32 v107, 0xbf800000, v105
  v_cvt_pk_bf16_f32 v106, v106, v107
  v_ashrrev_i32 v107, 16, v106
  v_bfe_i32 v106, v106, 0, 16
  v_subrev_u32 v106, 17024, v106
  v_subrev_u32 v108, 0, v104
  v_med3_i32 v106, v106, v108, s83
  v_max_i32 v108, 0, v106
  v_lshrrev_b32 v108, 3, v108
  v_add_u32 v108, v106, v108
  v_lshl_add_u32 v110, v108, 4, s82
  v_subrev_u32 v107, 17024, v107
  v_subrev_u32 v108, 1, v104
  v_med3_i32 v107, v107, v108, s83
  v_max_i32 v108, 0, v107
  v_lshrrev_b32 v108, 3, v108
  v_add_u32 v108, v107, v108
  v_lshl_add_u32 v111, v108, 4, s82
  v_add_f32 v106, 0xc0000000, v105
  v_add_f32 v107, 0xc0400000, v105
  v_cvt_pk_bf16_f32 v106, v106, v107
  v_ashrrev_i32 v107, 16, v106
  v_bfe_i32 v106, v106, 0, 16
  v_subrev_u32 v106, 17024, v106
  v_subrev_u32 v108, 2, v104
  v_med3_i32 v106, v106, v108, s83
  v_max_i32 v108, 0, v106
  v_lshrrev_b32 v108, 3, v108
  v_add_u32 v108, v106, v108
  v_lshl_add_u32 v112, v108, 4, s82
  v_subrev_u32 v107, 17024, v107
  v_subrev_u32 v108, 3, v104
  v_med3_i32 v107, v107, v108, s83
  v_max_i32 v108, 0, v107
  v_lshrrev_b32 v108, 3, v108
  v_add_u32 v108, v107, v108
  v_lshl_add_u32 v113, v108, 4, s82
  v_add_f32 v106, 0xc0800000, v105
  v_add_f32 v107, 0xc0a00000, v105
  v_cvt_pk_bf16_f32 v106, v106, v107
  v_ashrrev_i32 v107, 16, v106
  v_bfe_i32 v106, v106, 0, 16
  v_subrev_u32 v106, 17024, v106
  v_subrev_u32 v108, 4, v104
  v_med3_i32 v106, v106, v108, s83
  v_max_i32 v108, 0, v106
  v_lshrrev_b32 v108, 3, v108
  v_add_u32 v108, v106, v108
  v_lshl_add_u32 v114, v108, 4, s82
  v_subrev_u32 v107, 17024, v107
  v_subrev_u32 v108, 5, v104
  v_med3_i32 v107, v107, v108, s83
  v_max_i32 v108, 0, v107
  v_lshrrev_b32 v108, 3, v108
  v_add_u32 v108, v107, v108
  v_lshl_add_u32 v115, v108, 4, s82
  v_add_f32 v106, 0xc0c00000, v105
  v_add_f32 v107, 0xc0e00000, v105
  v_cvt_pk_bf16_f32 v106, v106, v107
  v_ashrrev_i32 v107, 16, v106
  v_bfe_i32 v106, v106, 0, 16
  v_subrev_u32 v106, 17024, v106
  v_subrev_u32 v108, 6, v104
  v_med3_i32 v106, v106, v108, s83
  v_max_i32 v108, 0, v106
  v_lshrrev_b32 v108, 3, v108
  v_add_u32 v108, v106, v108
  v_lshl_add_u32 v116, v108, 4, s82
  v_subrev_u32 v107, 17024, v107
  v_subrev_u32 v108, 7, v104
  v_med3_i32 v107, v107, v108, s83
  v_max_i32 v108, 0, v107
  v_lshrrev_b32 v108, 3, v108
  v_add_u32 v108, v107, v108
  v_lshl_add_u32 v117, v108, 4, s82
  v_add_f32 v106, 0xc1000000, v105
  v_add_f32 v107, 0xc1100000, v105
  v_cvt_pk_bf16_f32 v106, v106, v107
  v_ashrrev_i32 v107, 16, v106
  v_bfe_i32 v106, v106, 0, 16
  v_subrev_u32 v106, 17024, v106
  v_subrev_u32 v108, 8, v104
  v_med3_i32 v106, v106, v108, s83
  v_max_i32 v108, 0, v106
  v_lshrrev_b32 v108, 3, v108
  v_add_u32 v108, v106, v108
  v_lshl_add_u32 v118, v108, 4, s82
  v_subrev_u32 v107, 17024, v107
  v_subrev_u32 v108, 9, v104
  v_med3_i32 v107, v107, v108, s83
  v_max_i32 v108, 0, v107
  v_lshrrev_b32 v108, 3, v108
  v_add_u32 v108, v107, v108
  v_lshl_add_u32 v119, v108, 4, s82
  s_waitcnt lgkmcnt(0)
  s_lshl_b32 s70, s81, 16
  s_and_b32 s71, s81, 0xffff0000
  s_cmp_eq_u32 s76, 0
  s_cselect_b32 s81, s70, s71
  s_lshl_b32 s70, s78, 16
  s_and_b32 s71, s78, 0xffff0000
  s_cmp_eq_u32 s76, 0
  s_cselect_b32 s78, s70, s71
  s_mul_i32 s70, s75, 9216
  s_add_u32 s70, s70, 114688
  v_mul_u32_u24 v21, 144, v1
  v_add_u32 v21, s70, v21
  v_bfe_u32 v24, v1, 3, 2
  v_lshrrev_b32 v25, 5, v1
  v_lshlrev_b32 v25, 1, v25
  v_lshl_add_u32 v24, v24, 2, v25
  v_mul_u32_u24 v24, 144, v24
  v_bfe_u32 v25, v1, 2, 1
  v_lshl_add_u32 v24, v25, 5, v24
  v_add_u32 v22, s70, v24
  v_lshlrev_b32 v25, 3, v1
  v_and_b32 v25, 24, v25
  v_add_u32 v2, v22, v25
  s_lshl_b32 s82, s75, 2
  s_add_u32 s82, s82, 151584
  v_lshrrev_b32 v23, 4, v1
  v_and_b32 v24, 7, v1
  v_bfe_u32 v25, v1, 3, 1
  v_mul_u32_u24 v27, 144, v25
  v_add_u32 v27, v27, v24
  v_mad_u32_u24 v27, v23, 36, v27
  v_lshl_add_u32 v27, v27, 4, s82
  v_lshlrev_b32 v28, 2, v25
  v_xor_b32 v6, v27, v28
  v_and_b32 v27, 15, v1
  v_mul_u32_u24 v27, 18, v27
  v_lshl_add_u32 v27, v23, 2, v27
  v_lshrrev_b32 v28, 1, v23
  v_add_u32 v27, v27, v28
  v_lshl_add_u32 v27, v27, 4, s82
  v_and_b32 v28, 1, v1
  v_lshlrev_b32 v28, 2, v28
  v_xor_b32 v7, v27, v28
  v_sub_u32 v27, 2, v25
  v_lshrrev_b32 v28, v27, v24
  v_lshlrev_b32 v29, 4, v28
  v_lshl_add_u32 v29, v23, 2, v29
  v_lshlrev_b32 v29, v27, v29
  v_bfe_u32 v30, v24, 0, v27
  v_add_u32 v29, v29, v30
  v_lshl_add_u32 v29, v25, 7, v29
  v_and_b32 v28, 1, v28
  v_lshlrev_b32 v28, 2, v28
  v_lshlrev_b32 v27, v27, 1
  v_lshrrev_b32 v30, 3, v29
  v_add_u32 v30, v29, v30
  v_lshl_add_u32 v30, v30, 4, s82
  v_xor_b32 v3, v30, v28
  v_add_u32 v29, v29, v27
  v_lshrrev_b32 v30, 3, v29
  v_add_u32 v30, v29, v30
  v_lshl_add_u32 v30, v30, 4, s82
  v_xor_b32 v4, v30, v28
  v_add_u32 v29, v29, v27
  v_lshrrev_b32 v30, 3, v29
  v_add_u32 v30, v29, v30
  v_lshl_add_u32 v30, v30, 4, s82
  v_xor_b32 v5, v30, v28
  v_add_u32 v29, v29, v27
  v_lshrrev_b32 v30, 3, v29
  v_add_u32 v30, v29, v30
  v_lshl_add_u32 v30, v30, 4, s82
  v_xor_b32 v8, v30, v28
  v_mov_b32 v26, s81
  v_mul_f32 v26, 1069066811, v26
  v_exp_f32 v26, v26
  s_nop 0
  v_cvt_pk_bf16_f32 v26, v26, v26
  v_and_b32 v26, 0xffff0000, v26
  s_waitcnt vmcnt(2)
  v_lshlrev_b32 v16, 16, v16
  v_lshlrev_b32 v17, 16, v17
  v_lshlrev_b32 v18, 16, v18
  v_lshlrev_b32 v19, 16, v19
  v_mul_f32 v16, 1069066811, v16
  v_exp_f32 v16, v16
  s_nop 0
  v_cvt_pk_bf16_f32 v16, v16, v16
  v_and_b32 v16, 0xffff0000, v16
  v_mul_f32 v16, v16, v26
  v_mul_f32 v17, v17, v26
  v_mul_f32 v18, v18, v26
  v_mul_f32 v19, v19, v26
  v_mul_f32 v16, 0xbfb8aa3b, v16
  v_mul_f32 v17, 0.15915494, v17
  v_add_f32 v160, v18, v18
  v_add_f32 v161, v19, v19
  v_mul_f32 v52, 0x41000000, v16
  v_mul_f32 v53, 0x41000000, v17
  v_exp_f32 v52, v52
  v_fract_f32 v53, v53
  v_cos_f32 v130, v53
  v_sin_f32 v131, v53
  v_mul_f32 v130, v130, v52
  v_mul_f32 v131, v131, v52
  v_mul_f32 v52, 1.0, v16
  v_mul_f32 v53, 1.0, v17
  v_exp_f32 v52, v52
  v_fract_f32 v53, v53
  v_cos_f32 v120, v53
  v_sin_f32 v121, v53
  v_mul_f32 v120, v120, v52
  v_mul_f32 v121, v121, v52
  v_pk_mul_f32 v[52:53], v[130:131], v[130:131] op_sel:[1,1] op_sel_hi:[1,0] neg_lo:[1,0]
  v_pk_fma_f32 v[132:133], v[130:131], v[130:131], v[52:53] op_sel:[0,0,0] op_sel_hi:[0,1,1]
  v_pk_mul_f32 v[52:53], v[132:133], v[130:131] op_sel:[1,1] op_sel_hi:[1,0] neg_lo:[1,0]
  v_pk_fma_f32 v[134:135], v[132:133], v[130:131], v[52:53] op_sel:[0,0,0] op_sel_hi:[0,1,1]
  v_pk_mul_f32 v[52:53], v[132:133], v[132:133] op_sel:[1,1] op_sel_hi:[1,0] neg_lo:[1,0]
  v_pk_fma_f32 v[136:137], v[132:133], v[132:133], v[52:53] op_sel:[0,0,0] op_sel_hi:[0,1,1]
  v_pk_mul_f32 v[52:53], v[136:137], v[130:131] op_sel:[1,1] op_sel_hi:[1,0] neg_lo:[1,0]
  v_pk_fma_f32 v[138:139], v[136:137], v[130:131], v[52:53] op_sel:[0,0,0] op_sel_hi:[0,1,1]
  v_pk_mul_f32 v[52:53], v[136:137], v[132:133] op_sel:[1,1] op_sel_hi:[1,0] neg_lo:[1,0]
  v_pk_fma_f32 v[140:141], v[136:137], v[132:133], v[52:53] op_sel:[0,0,0] op_sel_hi:[0,1,1]
  v_pk_mul_f32 v[52:53], v[136:137], v[134:135] op_sel:[1,1] op_sel_hi:[1,0] neg_lo:[1,0]
  v_pk_fma_f32 v[142:143], v[136:137], v[134:135], v[52:53] op_sel:[0,0,0] op_sel_hi:[0,1,1]
  v_cvt_pk_bf16_f32 v36, 1.0, v130
  v_cvt_pk_bf16_f32 v37, v132, v134
  v_cvt_pk_bf16_f32 v38, v136, v138
  v_cvt_pk_bf16_f32 v39, v140, v142
  v_cvt_pk_bf16_f32 v40, 0, v131
  ds_write_b128 v21, v[36:39] offset:0
  v_cvt_pk_bf16_f32 v41, v133, v135
  v_cvt_pk_bf16_f32 v42, v137, v139
  v_cvt_pk_bf16_f32 v43, v141, v143
  v_pk_mul_f32 v[52:53], v[136:137], v[136:137] op_sel:[1,1] op_sel_hi:[1,0] neg_lo:[1,0]
  v_pk_fma_f32 v[144:145], v[136:137], v[136:137], v[52:53] op_sel:[0,0,0] op_sel_hi:[0,1,1]
  ds_write_b128 v21, v[40:43] offset:32
  v_pk_mul_f32 v[52:53], v[144:145], v[130:131] op_sel:[1,1] op_sel_hi:[1,0] neg_lo:[1,0]
  v_pk_fma_f32 v[146:147], v[144:145], v[130:131], v[52:53] op_sel:[0,0,0] op_sel_hi:[0,1,1]
  v_pk_mul_f32 v[52:53], v[144:145], v[132:133] op_sel:[1,1] op_sel_hi:[1,0] neg_lo:[1,0]
  v_pk_fma_f32 v[148:149], v[144:145], v[132:133], v[52:53] op_sel:[0,0,0] op_sel_hi:[0,1,1]
  v_pk_mul_f32 v[52:53], v[144:145], v[134:135] op_sel:[1,1] op_sel_hi:[1,0] neg_lo:[1,0]
  v_pk_fma_f32 v[150:151], v[144:145], v[134:135], v[52:53] op_sel:[0,0,0] op_sel_hi:[0,1,1]
  v_pk_mul_f32 v[52:53], v[144:145], v[136:137] op_sel:[1,1] op_sel_hi:[1,0] neg_lo:[1,0]
  v_pk_fma_f32 v[152:153], v[144:145], v[136:137], v[52:53] op_sel:[0,0,0] op_sel_hi:[0,1,1]
  v_pk_mul_f32 v[52:53], v[144:145], v[138:139] op_sel:[1,1] op_sel_hi:[1,0] neg_lo:[1,0]
  v_pk_fma_f32 v[154:155], v[144:145], v[138:139], v[52:53] op_sel:[0,0,0] op_sel_hi:[0,1,1]
  v_pk_mul_f32 v[52:53], v[144:145], v[140:141] op_sel:[1,1] op_sel_hi:[1,0] neg_lo:[1,0]
  v_pk_fma_f32 v[156:157], v[144:145], v[140:141], v[52:53] op_sel:[0,0,0] op_sel_hi:[0,1,1]
  v_pk_mul_f32 v[52:53], v[144:145], v[142:143] op_sel:[1,1] op_sel_hi:[1,0] neg_lo:[1,0]
  v_pk_fma_f32 v[158:159], v[144:145], v[142:143], v[52:53] op_sel:[0,0,0] op_sel_hi:[0,1,1]
  v_cvt_pk_bf16_f32 v44, v144, v146
  v_cvt_pk_bf16_f32 v45, v148, v150
  v_cvt_pk_bf16_f32 v46, v152, v154
  v_cvt_pk_bf16_f32 v47, v156, v158
  v_cvt_pk_bf16_f32 v48, v145, v147
  ds_write_b128 v21, v[44:47] offset:16
  v_cvt_pk_bf16_f32 v49, v149, v151
  v_cvt_pk_bf16_f32 v50, v153, v155
  v_cvt_pk_bf16_f32 v51, v157, v159
  v_pk_mul_f32 v[52:53], v[144:145], v[144:145] op_sel:[1,1] op_sel_hi:[1,0] neg_lo:[1,0]
  v_pk_fma_f32 v[122:123], v[144:145], v[144:145], v[52:53] op_sel:[0,0,0] op_sel_hi:[0,1,1]
  ds_write_b128 v21, v[48:51] offset:48
  ds_read_b64_tr_b16 v[64:65], v2 offset:0
  ds_read_b64_tr_b16 v[66:67], v2 offset:144
  ds_read_b64_tr_b16 v[68:69], v2 offset:2304
  ds_read_b64_tr_b16 v[70:71], v2 offset:2448
  ds_read_b64_tr_b16 v[72:73], v2 offset:4608
  ds_read_b64_tr_b16 v[74:75], v2 offset:4752
  ds_read_b64_tr_b16 v[76:77], v2 offset:6912
  ds_read_b64_tr_b16 v[78:79], v2 offset:7056
  v_pk_mul_f32 v[52:53], v[160:161], v[120:121] op_sel:[1,1] op_sel_hi:[1,0] neg_lo:[1,0]
  v_pk_fma_f32 v[162:163], v[160:161], v[120:121], v[52:53] op_sel:[0,0,0] op_sel_hi:[0,1,1]
  v_pk_mul_f32 v[52:53], v[162:163], v[120:121] op_sel:[1,1] op_sel_hi:[1,0] neg_lo:[1,0]
  v_pk_fma_f32 v[164:165], v[162:163], v[120:121], v[52:53] op_sel:[0,0,0] op_sel_hi:[0,1,1]
  v_pk_mul_f32 v[52:53], v[164:165], v[120:121] op_sel:[1,1] op_sel_hi:[1,0] neg_lo:[1,0]
  v_pk_fma_f32 v[166:167], v[164:165], v[120:121], v[52:53] op_sel:[0,0,0] op_sel_hi:[0,1,1]
  v_pk_mul_f32 v[52:53], v[166:167], v[120:121] op_sel:[1,1] op_sel_hi:[1,0] neg_lo:[1,0]
  v_pk_fma_f32 v[168:169], v[166:167], v[120:121], v[52:53] op_sel:[0,0,0] op_sel_hi:[0,1,1]
  v_pk_mul_f32 v[52:53], v[168:169], v[120:121] op_sel:[1,1] op_sel_hi:[1,0] neg_lo:[1,0]
  v_pk_fma_f32 v[170:171], v[168:169], v[120:121], v[52:53] op_sel:[0,0,0] op_sel_hi:[0,1,1]
  v_pk_mul_f32 v[52:53], v[170:171], v[120:121] op_sel:[1,1] op_sel_hi:[1,0] neg_lo:[1,0]
  v_pk_fma_f32 v[172:173], v[170:171], v[120:121], v[52:53] op_sel:[0,0,0] op_sel_hi:[0,1,1]
  v_pk_mul_f32 v[52:53], v[172:173], v[120:121] op_sel:[1,1] op_sel_hi:[1,0] neg_lo:[1,0]
  v_pk_fma_f32 v[174:175], v[172:173], v[120:121], v[52:53] op_sel:[0,0,0] op_sel_hi:[0,1,1]
  v_cvt_pk_bf16_f32 v96, v160, v162
  v_cvt_pk_bf16_f32 v97, v164, v166
  v_cvt_pk_bf16_f32 v98, v168, v170
  v_cvt_pk_bf16_f32 v99, v172, v174
  v_cvt_pk_bf16_f32 v100, -v161, -v163
  ds_write_b128 v21, v[96:99] offset:64
  v_cvt_pk_bf16_f32 v101, -v165, -v167
  v_cvt_pk_bf16_f32 v102, -v169, -v171
  v_cvt_pk_bf16_f32 v103, -v173, -v175
  v_pk_mul_f32 v[52:53], v[160:161], v[122:123] op_sel:[1,1] op_sel_hi:[1,0] neg_lo:[1,0]
  v_pk_fma_f32 v[176:177], v[160:161], v[122:123], v[52:53] op_sel:[0,0,0] op_sel_hi:[0,1,1]
  ds_write_b128 v21, v[100:103] offset:96
  v_pk_mul_f32 v[52:53], v[162:163], v[122:123] op_sel:[1,1] op_sel_hi:[1,0] neg_lo:[1,0]
  v_pk_fma_f32 v[178:179], v[162:163], v[122:123], v[52:53] op_sel:[0,0,0] op_sel_hi:[0,1,1]
  v_pk_mul_f32 v[52:53], v[164:165], v[122:123] op_sel:[1,1] op_sel_hi:[1,0] neg_lo:[1,0]
  v_pk_fma_f32 v[180:181], v[164:165], v[122:123], v[52:53] op_sel:[0,0,0] op_sel_hi:[0,1,1]
  v_pk_mul_f32 v[52:53], v[166:167], v[122:123] op_sel:[1,1] op_sel_hi:[1,0] neg_lo:[1,0]
  v_pk_fma_f32 v[182:183], v[166:167], v[122:123], v[52:53] op_sel:[0,0,0] op_sel_hi:[0,1,1]
  v_pk_mul_f32 v[52:53], v[168:169], v[122:123] op_sel:[1,1] op_sel_hi:[1,0] neg_lo:[1,0]
  v_pk_fma_f32 v[184:185], v[168:169], v[122:123], v[52:53] op_sel:[0,0,0] op_sel_hi:[0,1,1]
  v_pk_mul_f32 v[52:53], v[170:171], v[122:123] op_sel:[1,1] op_sel_hi:[1,0] neg_lo:[1,0]
  v_pk_fma_f32 v[186:187], v[170:171], v[122:123], v[52:53] op_sel:[0,0,0] op_sel_hi:[0,1,1]
  v_pk_mul_f32 v[52:53], v[172:173], v[122:123] op_sel:[1,1] op_sel_hi:[1,0] neg_lo:[1,0]
  v_pk_fma_f32 v[188:189], v[172:173], v[122:123], v[52:53] op_sel:[0,0,0] op_sel_hi:[0,1,1]
  v_pk_mul_f32 v[52:53], v[174:175], v[122:123] op_sel:[1,1] op_sel_hi:[1,0] neg_lo:[1,0]
  v_pk_fma_f32 v[190:191], v[174:175], v[122:123], v[52:53] op_sel:[0,0,0] op_sel_hi:[0,1,1]
  v_cvt_pk_bf16_f32 v212, v176, v178
  v_cvt_pk_bf16_f32 v213, v180, v182
  v_cvt_pk_bf16_f32 v214, v184, v186
  v_cvt_pk_bf16_f32 v215, v188, v190
  v_cvt_pk_bf16_f32 v216, -v177, -v179
  ds_write_b128 v21, v[212:215] offset:80
  v_cvt_pk_bf16_f32 v217, -v181, -v183
  v_cvt_pk_bf16_f32 v218, -v185, -v187
  v_cvt_pk_bf16_f32 v219, -v189, -v191
  v_pk_mul_f32 v[52:53], v[122:123], v[122:123] op_sel:[1,1] op_sel_hi:[1,0] neg_lo:[1,0]
  v_pk_fma_f32 v[124:125], v[122:123], v[122:123], v[52:53] op_sel:[0,0,0] op_sel_hi:[0,1,1]
  ds_write_b128 v21, v[216:219] offset:112
  ds_read_b64_tr_b16 v[80:81], v2 offset:64
  ds_read_b64_tr_b16 v[82:83], v2 offset:208
  ds_read_b64_tr_b16 v[84:85], v2 offset:2368
  ds_read_b64_tr_b16 v[86:87], v2 offset:2512
  ds_read_b64_tr_b16 v[88:89], v2 offset:4672
  ds_read_b64_tr_b16 v[90:91], v2 offset:4816
  ds_read_b64_tr_b16 v[92:93], v2 offset:6976
  ds_read_b64_tr_b16 v[94:95], v2 offset:7120
  v_pk_mul_f32 v[52:53], v[160:161], v[124:125] op_sel:[1,1] op_sel_hi:[1,0] neg_lo:[1,0]
  v_pk_fma_f32 v[130:131], v[160:161], v[124:125], v[52:53] op_sel:[0,0,0] op_sel_hi:[0,1,1]
  v_pk_mul_f32 v[52:53], v[164:165], v[124:125] op_sel:[1,1] op_sel_hi:[1,0] neg_lo:[1,0]
  v_pk_fma_f32 v[132:133], v[164:165], v[124:125], v[52:53] op_sel:[0,0,0] op_sel_hi:[0,1,1]
  v_pk_mul_f32 v[52:53], v[168:169], v[124:125] op_sel:[1,1] op_sel_hi:[1,0] neg_lo:[1,0]
  v_pk_fma_f32 v[134:135], v[168:169], v[124:125], v[52:53] op_sel:[0,0,0] op_sel_hi:[0,1,1]
  v_pk_mul_f32 v[52:53], v[172:173], v[124:125] op_sel:[1,1] op_sel_hi:[1,0] neg_lo:[1,0]
  v_pk_fma_f32 v[136:137], v[172:173], v[124:125], v[52:53] op_sel:[0,0,0] op_sel_hi:[0,1,1]
  v_pk_mul_f32 v[52:53], v[176:177], v[124:125] op_sel:[1,1] op_sel_hi:[1,0] neg_lo:[1,0]
  v_pk_fma_f32 v[138:139], v[176:177], v[124:125], v[52:53] op_sel:[0,0,0] op_sel_hi:[0,1,1]
  v_pk_mul_f32 v[52:53], v[180:181], v[124:125] op_sel:[1,1] op_sel_hi:[1,0] neg_lo:[1,0]
  v_pk_fma_f32 v[140:141], v[180:181], v[124:125], v[52:53] op_sel:[0,0,0] op_sel_hi:[0,1,1]
  v_pk_mul_f32 v[52:53], v[184:185], v[124:125] op_sel:[1,1] op_sel_hi:[1,0] neg_lo:[1,0]
  v_pk_fma_f32 v[142:143], v[184:185], v[124:125], v[52:53] op_sel:[0,0,0] op_sel_hi:[0,1,1]
  s_waitcnt lgkmcnt(6)
  v_mfma_f32_16x16x32_bf16 v[60:63], v[64:67], v[80:83], 0
  s_waitcnt lgkmcnt(4)
  v_mfma_f32_16x16x32_bf16 v[60:63], v[68:71], v[84:87], v[60:63]
  s_waitcnt lgkmcnt(2)
  v_mfma_f32_16x16x32_bf16 v[60:63], v[72:75], v[88:91], v[60:63]
  s_waitcnt lgkmcnt(0)
  v_mfma_f32_16x16x32_bf16 v[60:63], v[76:79], v[92:95], v[60:63]
  v_pk_mul_f32 v[52:53], v[188:189], v[124:125] op_sel:[1,1] op_sel_hi:[1,0] neg_lo:[1,0]
  v_pk_fma_f32 v[144:145], v[188:189], v[124:125], v[52:53] op_sel:[0,0,0] op_sel_hi:[0,1,1]
  v_cvt_pk_bf16_f32 v36, v130, v132
  v_cvt_pk_bf16_f32 v37, v134, v136
  v_cvt_pk_bf16_f32 v38, v138, v140
  v_cvt_pk_bf16_f32 v39, v142, v144
  v_cvt_pk_bf16_f32 v40, -v131, -v133
  ds_write_b128 v21, v[36:39] offset:0
  v_cvt_pk_bf16_f32 v41, -v135, -v137
  v_cvt_pk_bf16_f32 v42, -v139, -v141
  v_cvt_pk_bf16_f32 v43, -v143, -v145
  v_pk_mul_f32 v[52:53], v[124:125], v[124:125] op_sel:[1,1] op_sel_hi:[1,0] neg_lo:[1,0]
  v_pk_fma_f32 v[126:127], v[124:125], v[124:125], v[52:53] op_sel:[0,0,0] op_sel_hi:[0,1,1]
  ds_write_b32 v6, v60 offset:0
  ds_write_b32 v6, v61 offset:144
  ds_write_b32 v6, v62 offset:288
  ds_write_b32 v6, v63 offset:432
  v_pk_mul_f32 v[52:53], v[160:161], v[126:127] op_sel:[1,1] op_sel_hi:[1,0] neg_lo:[1,0]
  v_pk_fma_f32 v[146:147], v[160:161], v[126:127], v[52:53] op_sel:[0,0,0] op_sel_hi:[0,1,1]
  v_pk_mul_f32 v[52:53], v[168:169], v[126:127] op_sel:[1,1] op_sel_hi:[1,0] neg_lo:[1,0]
  v_pk_fma_f32 v[148:149], v[168:169], v[126:127], v[52:53] op_sel:[0,0,0] op_sel_hi:[0,1,1]
  v_pk_mul_f32 v[52:53], v[176:177], v[126:127] op_sel:[1,1] op_sel_hi:[1,0] neg_lo:[1,0]
  ds_write_b128 v21, v[40:43] offset:32
  v_pk_fma_f32 v[150:151], v[176:177], v[126:127], v[52:53] op_sel:[0,0,0] op_sel_hi:[0,1,1]
  v_pk_mul_f32 v[52:53], v[184:185], v[126:127] op_sel:[1,1] op_sel_hi:[1,0] neg_lo:[1,0]
  v_pk_fma_f32 v[152:153], v[184:185], v[126:127], v[52:53] op_sel:[0,0,0] op_sel_hi:[0,1,1]
  v_pk_mul_f32 v[52:53], v[130:131], v[126:127] op_sel:[1,1] op_sel_hi:[1,0] neg_lo:[1,0]
  v_pk_fma_f32 v[154:155], v[130:131], v[126:127], v[52:53] op_sel:[0,0,0] op_sel_hi:[0,1,1]
  v_pk_mul_f32 v[52:53], v[134:135], v[126:127] op_sel:[1,1] op_sel_hi:[1,0] neg_lo:[1,0]
  v_pk_fma_f32 v[156:157], v[134:135], v[126:127], v[52:53] op_sel:[0,0,0] op_sel_hi:[0,1,1]
  v_pk_mul_f32 v[52:53], v[138:139], v[126:127] op_sel:[1,1] op_sel_hi:[1,0] neg_lo:[1,0]
  v_pk_fma_f32 v[158:159], v[138:139], v[126:127], v[52:53] op_sel:[0,0,0] op_sel_hi:[0,1,1]
  v_pk_mul_f32 v[52:53], v[142:143], v[126:127] op_sel:[1,1] op_sel_hi:[1,0] neg_lo:[1,0]
  v_pk_fma_f32 v[192:193], v[142:143], v[126:127], v[52:53] op_sel:[0,0,0] op_sel_hi:[0,1,1]
  v_cvt_pk_bf16_f32 v44, v146, v148
  v_cvt_pk_bf16_f32 v45, v150, v152
  v_cvt_pk_bf16_f32 v46, v154, v156
  v_cvt_pk_bf16_f32 v47, v158, v192
  v_cvt_pk_bf16_f32 v48, -v147, -v149
  ds_write_b128 v21, v[44:47] offset:16
  v_cvt_pk_bf16_f32 v49, -v151, -v153
  v_cvt_pk_bf16_f32 v50, -v155, -v157
  v_cvt_pk_bf16_f32 v51, -v159, -v193
  v_pk_mul_f32 v[52:53], v[126:127], v[126:127] op_sel:[1,1] op_sel_hi:[1,0] neg_lo:[1,0]
  v_pk_fma_f32 v[128:129], v[126:127], v[126:127], v[52:53] op_sel:[0,0,0] op_sel_hi:[0,1,1]
  ds_write_b128 v21, v[48:51] offset:48
  ds_read_b64_tr_b16 v[224:225], v2 offset:0
  ds_read_b64_tr_b16 v[226:227], v2 offset:144
  ds_read_b64_tr_b16 v[228:229], v2 offset:2304
  ds_read_b64_tr_b16 v[230:231], v2 offset:2448
  ds_read_b64_tr_b16 v[232:233], v2 offset:4608
  ds_read_b64_tr_b16 v[234:235], v2 offset:4752
  ds_read_b64_tr_b16 v[236:237], v2 offset:6912
  ds_read_b64_tr_b16 v[238:239], v2 offset:7056
  v_pk_mul_f32 v[52:53], v[160:161], v[128:129] op_sel:[1,1] op_sel_hi:[1,0] neg_lo:[1,0]
  v_pk_fma_f32 v[194:195], v[160:161], v[128:129], v[52:53] op_sel:[0,0,0] op_sel_hi:[0,1,1]
  v_pk_mul_f32 v[52:53], v[176:177], v[128:129] op_sel:[1,1] op_sel_hi:[1,0] neg_lo:[1,0]
  v_pk_fma_f32 v[196:197], v[176:177], v[128:129], v[52:53] op_sel:[0,0,0] op_sel_hi:[0,1,1]
  v_pk_mul_f32 v[52:53], v[130:131], v[128:129] op_sel:[1,1] op_sel_hi:[1,0] neg_lo:[1,0]
  v_pk_fma_f32 v[198:199], v[130:131], v[128:129], v[52:53] op_sel:[0,0,0] op_sel_hi:[0,1,1]
  v_pk_mul_f32 v[52:53], v[138:139], v[128:129] op_sel:[1,1] op_sel_hi:[1,0] neg_lo:[1,0]
  v_pk_fma_f32 v[200:201], v[138:139], v[128:129], v[52:53] op_sel:[0,0,0] op_sel_hi:[0,1,1]
  v_pk_mul_f32 v[52:53], v[146:147], v[128:129] op_sel:[1,1] op_sel_hi:[1,0] neg_lo:[1,0]
  v_pk_fma_f32 v[202:203], v[146:147], v[128:129], v[52:53] op_sel:[0,0,0] op_sel_hi:[0,1,1]
  v_pk_mul_f32 v[52:53], v[150:151], v[128:129] op_sel:[1,1] op_sel_hi:[1,0] neg_lo:[1,0]
  v_pk_fma_f32 v[204:205], v[150:151], v[128:129], v[52:53] op_sel:[0,0,0] op_sel_hi:[0,1,1]
  v_pk_mul_f32 v[52:53], v[154:155], v[128:129] op_sel:[1,1] op_sel_hi:[1,0] neg_lo:[1,0]
  v_pk_fma_f32 v[206:207], v[154:155], v[128:129], v[52:53] op_sel:[0,0,0] op_sel_hi:[0,1,1]
  s_waitcnt lgkmcnt(6)
  v_mfma_f32_16x16x32_bf16 v[56:59], v[64:67], v[224:227], 0
  s_waitcnt lgkmcnt(4)
  v_mfma_f32_16x16x32_bf16 v[56:59], v[68:71], v[228:231], v[56:59]
  s_waitcnt lgkmcnt(2)
  v_mfma_f32_16x16x32_bf16 v[56:59], v[72:75], v[232:235], v[56:59]
  s_waitcnt lgkmcnt(0)
  v_mfma_f32_16x16x32_bf16 v[56:59], v[76:79], v[236:239], v[56:59]
  v_pk_mul_f32 v[52:53], v[158:159], v[128:129] op_sel:[1,1] op_sel_hi:[1,0] neg_lo:[1,0]
  v_pk_fma_f32 v[208:209], v[158:159], v[128:129], v[52:53] op_sel:[0,0,0] op_sel_hi:[0,1,1]
  v_pk_mul_f32 v[52:53], v[194:195], v[128:129] op_sel:[1,1] op_sel_hi:[1,0] neg_lo:[1,0]
  v_pk_fma_f32 v[210:211], v[194:195], v[128:129], v[52:53] op_sel:[0,0,0] op_sel_hi:[0,1,1]
  v_cvt_pk_bf16_f32 v96, v194, v196
  v_cvt_pk_bf16_f32 v97, v198, v200
  v_cvt_pk_bf16_f32 v98, v202, v204
  v_cvt_pk_bf16_f32 v99, v206, v208
  v_cvt_pk_bf16_f32 v100, -v195, -v197
  ds_write_b128 v21, v[96:99] offset:64
  v_cvt_pk_bf16_f32 v101, -v199, -v201
  v_cvt_pk_bf16_f32 v102, -v203, -v205
  v_cvt_pk_bf16_f32 v103, -v207, -v209
  ds_write_b32 v3, v56 offset:4608
  ds_write_b32 v4, v57 offset:4608
  ds_write_b32 v5, v58 offset:4608
  ds_write_b32 v8, v59 offset:4608
  v_cvt_pk_bf16_f32 v212, v210, v210
  v_cvt_pk_bf16_f32 v216, -v211, -v211
  ds_write_b128 v21, v[100:103] offset:96
  ds_write_b32 v21, v212 offset:80
  ds_write_b32 v21, v216 offset:112
  ds_read_b64_tr_b16 v[80:81], v2 offset:64
  ds_read_b64_tr_b16 v[82:83], v2 offset:208
  ds_read_b64_tr_b16 v[84:85], v2 offset:2368
  ds_read_b64_tr_b16 v[86:87], v2 offset:2512
  ds_read_b64_tr_b16 v[88:89], v2 offset:4672
  ds_read_b64_tr_b16 v[90:91], v2 offset:4816
  ds_read_b64_tr_b16 v[92:93], v2 offset:6976
  ds_read_b64_tr_b16 v[94:95], v2 offset:7120
  s_waitcnt lgkmcnt(6)
  v_mfma_f32_16x16x32_bf16 v[240:243], v[64:67], v[80:83], 0
  s_waitcnt lgkmcnt(4)
  v_mfma_f32_16x16x32_bf16 v[240:243], v[68:71], v[84:87], v[240:243]
  s_waitcnt lgkmcnt(2)
  v_mfma_f32_16x16x32_bf16 v[240:243], v[72:75], v[88:91], v[240:243]
  s_waitcnt lgkmcnt(0)
  v_mfma_f32_16x16x32_bf16 v[240:243], v[76:79], v[92:95], v[240:243]
  s_mov_b32 exec_lo, 0x1ff01ff
  s_mov_b32 exec_hi, 0x1ff01ff
  s_nop 5
  ds_write_b32 v7, v240 offset:9216
  ds_write_b32 v7, v241 offset:9232
  ds_write_b32 v7, v242 offset:9248
  ds_write_b32 v7, v243 offset:9264
  s_mov_b64 exec, -1
  s_waitcnt lgkmcnt(0)
  s_barrier
  ds_read_b128 v[64:67], v110
  ds_read_b128 v[68:71], v111
  ds_read_b128 v[72:75], v112
  ds_read_b128 v[76:79], v113
  s_waitcnt lgkmcnt(0)
  s_barrier
  ds_read_b128 v[80:83], v114
  ds_read_b128 v[84:87], v115
  ds_read_b128 v[88:91], v116
  s_waitcnt lgkmcnt(0)
  s_barrier
  ds_read_b128 v[92:95], v117
  ds_read_b128 v[96:99], v118
  ds_read_b128 v[100:103], v119
  s_waitcnt lgkmcnt(0)
  s_barrier
  s_lshl_b32 s70, s75, 10
  s_add_u32 s70, s70, 114688
  v_lshl_add_u32 v16, v1, 4, s70
  v_add_f32 v24, v64, v65
  v_add_f32 v25, v66, v67
  v_add_f32 v26, v68, v69
  v_add_f32 v27, v70, v71
  v_add_f32 v28, v72, v73
  v_add_f32 v29, v74, v75
  v_add_f32 v30, v76, v77
  v_add_f32 v31, v78, v79
  v_add_f32 v32, v80, v81
  v_add_f32 v33, v82, v83
  v_add_f32 v34, v84, v85
  s_barrier
  v_add_f32 v35, v86, v87
  v_add_f32 v36, v88, v89
  v_add_f32 v37, v90, v91
  v_add_f32 v38, v92, v93
  v_add_f32 v39, v94, v95
  v_add_f32 v40, v96, v97
  v_add_f32 v41, v98, v99
  v_add_f32 v42, v100, v101
  v_add_f32 v43, v102, v103
  v_cvt_pk_bf16_f32 v44, v24, v26
  v_cvt_pk_bf16_f32 v45, v28, v30
  v_cvt_pk_bf16_f32 v46, v32, v34
  v_cvt_pk_bf16_f32 v47, v36, v38
  s_barrier
  ds_write_b128 v16, v[44:47] offset:0
  v_cvt_pk_bf16_f32 v48, v28, v30
  v_cvt_pk_bf16_f32 v49, v32, v34
  v_cvt_pk_bf16_f32 v50, v36, v38
  v_cvt_pk_bf16_f32 v51, v40, v42
  s_waitcnt lgkmcnt(0)
  s_barrier
  ds_write_b128 v16, v[48:51] offset:4224
  v_cvt_pk_bf16_f32 v52, v25, v27
  v_cvt_pk_bf16_f32 v53, v29, v31
  v_cvt_pk_bf16_f32 v54, v33, v35
  v_cvt_pk_bf16_f32 v55, v37, v39
  s_waitcnt lgkmcnt(0)
  s_barrier
  ds_write_b128 v16, v[52:55] offset:17728
  v_cvt_pk_bf16_f32 v56, v29, v31
  v_cvt_pk_bf16_f32 v57, v33, v35
  v_cvt_pk_bf16_f32 v58, v37, v39
  v_cvt_pk_bf16_f32 v59, v41, v43
  s_waitcnt lgkmcnt(0)
  s_barrier
  ds_write_b128 v16, v[56:59] offset:21952
  v_mov_b32 v60, 0
  v_mov_b32 v61, 0
  v_mov_b32 v62, 0
  v_mov_b32 v63, 0
  s_waitcnt lgkmcnt(0)
  s_barrier
  v_lshrrev_b32 v9, 3, v1
  v_and_b32 v10, 7, v1
  v_lshlrev_b32 v10, 7, v10
  v_lshl_add_u32 v9, v9, 10, v10
  s_lshl_b32 s70, s2, 13
  s_cmp_lg_u32 s75, 0
  s_cbranch_scc1 Lw6
  s_waitcnt vmcnt(1)
  buffer_load_dword v220, v9, s[52:55], s70 offen
Lw6:
  s_mov_b64 exec, -1
  s_mul_i32 s70, s77, 4224
  s_add_u32 s70, s70, s80
  v_and_b32 v17, 3, v1
  v_lshl_add_u32 v17, v17, 4, s70
  ds_write_b128 v17, v[60:63] offset:4096
  s_waitcnt lgkmcnt(0)
  s_barrier
  s_mul_i32 s70, s77, 4640
  s_add_u32 s70, s70, s80
  v_min_u32 v17, 27, v1
  v_lshl_add_u32 v17, v17, 4, s70
  ds_write_b128 v17, v[60:63] offset:8448
  s_waitcnt lgkmcnt(0)
  s_barrier
  s_cmp_lg_u32 s75, 0
  s_cbranch_scc1 Lw7
  buffer_load_dword v10, off, s[64:67], 0 offset:128 sc1
Lw7:
  s_barrier
  v_mov_b32 v12, 163776
  s_cmp_lg_u32 s75, 0
  s_cbranch_scc1 Lw8
  s_waitcnt vmcnt(0)
  v_cmp_eq_u32 vcc, 0, v10
  s_cbranch_vccz Lk10
  s_mov_b32 s69, 4096
Lp9:
  buffer_load_dword v10, off, s[64:67], 0 offset:128 sc1
  s_waitcnt vmcnt(0)
  v_cmp_eq_u32 vcc, 0, v10
  s_cbranch_vccz Lk10
  s_sub_u32 s69, s69, 1
  s_cbranch_scc0 Lp9
Lk10:
  s_nop 0
  s_nop 0
  ds_write_b32 v12, v10
Lw8:
  s_waitcnt lgkmcnt(0)
  s_mov_b32 s69, 131072
Lp11:
  ds_read_b32 v11, v12
  s_waitcnt lgkmcnt(0)
  v_cmp_eq_u32 vcc, 0, v11
  s_cbranch_vccz Lk12
  s_sub_u32 s69, s69, 1
  s_cbranch_scc0 Lp11
Lk12:
  s_nop 0
  s_nop 0
  v_lshrrev_b32 v16, 3, v1
  v_and_b32 v17, 7, v1
  v_lshlrev_b32 v18, 15, v16
  v_lshl_add_u32 v18, v17, 4, v18
  s_lshl_b32 s70, s75, 19
  s_lshl_b32 s71, s87, 7
  s_add_u32 s70, s70, s71
  v_add_u32 v18, s70, v18
  v_and_b32 v19, 3, v1
  v_cmp_eq_u32 vcc, 0, v19
  v_mov_b32 v20, 4
  v_mov_b32 v21, 32708
  v_cndmask_b32 v20, v20, v21, vcc
  v_sub_u32 v20, v18, v20
  s_mov_b32 s82, 262144
  v_add_u32 v21, s82, v20
  v_min_u32 v20, 0x7fff0000, v20
  buffer_load_dwordx4 v[24:27], v18, s[56:59], 0 offen sc1
  buffer_load_dword v32, v20, s[56:59], 0 offen sc1
  buffer_load_dwordx4 v[28:31], v18, s[56:59], s82 offen sc1
  buffer_load_dword v33, v21, s[56:59], 0 offen sc1
  v_bfe_u32 v17, v1, 2, 1
  v_mul_u32_u24 v17, 17728, v17
  v_lshl_add_u32 v17, v16, 6, v17
  v_lshl_add_u32 v17, v19, 4, v17
  s_lshl_b32 s70, s75, 10
  s_add_u32 s70, s70, 115136
  v_add_u32 v17, s70, v17
  s_barrier
  s_barrier
  s_waitcnt vmcnt(3)
  ds_write_b128 v17, v[24:27] offset:13088
  s_waitcnt vmcnt(2)
  v_alignbit_b32 v36, v24, v32, 16
  v_alignbit_b32 v37, v25, v24, 16
  v_alignbit_b32 v38, v26, v25, 16
  v_alignbit_b32 v39, v27, v26, 16
  ds_write_b128 v17, v[36:39] offset:8448
  s_waitcnt lgkmcnt(0)
  s_barrier
  s_waitcnt vmcnt(1)
  ds_write_b128 v17, v[28:31] offset:13600
  s_waitcnt vmcnt(0)
  v_alignbit_b32 v40, v28, v33, 16
  v_alignbit_b32 v41, v29, v28, 16
  v_alignbit_b32 v42, v30, v29, 16
  v_alignbit_b32 v43, v31, v30, 16
  ds_write_b128 v17, v[40:43] offset:8960
  s_waitcnt lgkmcnt(0)
  s_barrier
LCONV:
  s_setprio 0
  v_and_b32 v4, 15, v1
  v_lshrrev_b32 v5, 4, v1
  v_and_b32 v6, 1, v1
  v_lshlrev_b32 v7, 4, v5
  v_mul_u32_u24 v2, 4640, v6
  v_lshrrev_b32 v8, 1, v4
  v_lshl_add_u32 v2, v8, 6, v2
  s_lshl_b32 s71, s77, 8
  s_sub_u32 s70, s80, s71
  s_add_u32 s82, s70, 8704
  v_add3_u32 v2, v2, v7, s82
  v_mul_u32_u24 v3, 4220, v6
  v_lshlrev_b32 v8, 2, v4
  v_add_u32 v3, v3, v8
  v_sub_u32 v3, v7, v3
  s_add_u32 s82, s70, 4536
  v_add_u32 v3, s82, v3
  ds_read_b64 v[96:97], v3 offset:3776
  ds_read_b64 v[98:99], v3 offset:3784
  ds_read_b128 v[64:67], v2 offset:192
  ds_read_b128 v[68:71], v2 offset:704
  ds_read_b128 v[72:75], v2 offset:1216
  ds_read_b128 v[76:79], v2 offset:1728
  ds_read_b128 v[80:83], v2 offset:2240
  ds_read_b128 v[84:87], v2 offset:2752
  ds_read_b128 v[88:91], v2 offset:3264
  ds_read_b128 v[92:95], v2 offset:3776
  ds_read_b64 v[100:101], v3 offset:3264
  ds_read_b64 v[102:103], v3 offset:3272
  ds_read_b64 v[104:105], v3 offset:2752
  ds_read_b64 v[106:107], v3 offset:2760
  ds_read_b64 v[108:109], v3 offset:2240
  ds_read_b64 v[110:111], v3 offset:2248
  ds_read_b64 v[112:113], v3 offset:1728
  ds_read_b64 v[114:115], v3 offset:1736
  ds_read_b64 v[116:117], v3 offset:1216
  ds_read_b64 v[118:119], v3 offset:1224
  ds_read_b64 v[120:121], v3 offset:704
  ds_read_b64 v[122:123], v3 offset:712
  ds_read_b64 v[124:125], v3 offset:192
  ds_read_b64 v[126:127], v3 offset:200
  s_lshl_b32 s70, s75, 2
  s_add_u32 s70, s70, 163712
  v_mov_b32 v9, s70
  s_xor_b32 s70, s70, 4
  v_mov_b32 v10, s70
  v_mov_b32 v11, 1
  s_waitcnt lgkmcnt(15)
  v_mfma_f32_16x16x32_bf16 v[32:35], v[64:67], v[96:99], 0
  ds_read_b64 v[160:161], v3 offset:3712
  v_mfma_f32_16x16x32_bf16 v[36:39], v[68:71], v[96:99], 0
  ds_read_b64 v[162:163], v3 offset:3720
  v_mfma_f32_16x16x32_bf16 v[40:43], v[72:75], v[96:99], 0
  ds_read_b128 v[128:131], v2 offset:128
  v_mfma_f32_16x16x32_bf16 v[44:47], v[76:79], v[96:99], 0
  ds_read_b128 v[132:135], v2 offset:640
  v_mfma_f32_16x16x32_bf16 v[48:51], v[80:83], v[96:99], 0
  ds_read_b128 v[136:139], v2 offset:1152
  v_mfma_f32_16x16x32_bf16 v[52:55], v[84:87], v[96:99], 0
  ds_read_b128 v[140:143], v2 offset:1664
  v_mfma_f32_16x16x32_bf16 v[56:59], v[88:91], v[96:99], 0
  ds_read_b128 v[144:147], v2 offset:2176
  s_waitcnt lgkmcnt(15)
  v_mfma_f32_16x16x32_bf16 v[60:63], v[92:95], v[96:99], 0
  ds_read_b128 v[148:151], v2 offset:2688
  v_mfma_f32_16x16x32_bf16 v[36:39], v[64:67], v[100:103], v[36:39]
  ds_read_b128 v[152:155], v2 offset:3200
  v_mfma_f32_16x16x32_bf16 v[40:43], v[68:71], v[100:103], v[40:43]
  ds_read_b128 v[156:159], v2 offset:3712
  v_mfma_f32_16x16x32_bf16 v[44:47], v[72:75], v[100:103], v[44:47]
  ds_read_b64 v[164:165], v3 offset:3200
  v_mfma_f32_16x16x32_bf16 v[48:51], v[76:79], v[100:103], v[48:51]
  ds_read_b64 v[166:167], v3 offset:3208
  v_mfma_f32_16x16x32_bf16 v[52:55], v[80:83], v[100:103], v[52:55]
  ds_read_b64 v[168:169], v3 offset:2688
  v_mfma_f32_16x16x32_bf16 v[56:59], v[84:87], v[100:103], v[56:59]
  ds_read_b64 v[170:171], v3 offset:2696
  v_mfma_f32_16x16x32_bf16 v[60:63], v[88:91], v[100:103], v[60:63]
  ds_read_b64 v[172:173], v3 offset:2176
  v_mfma_f32_16x16x32_bf16 v[40:43], v[64:67], v[104:107], v[40:43]
  ds_read_b64 v[174:175], v3 offset:2184
  v_mfma_f32_16x16x32_bf16 v[44:47], v[68:71], v[104:107], v[44:47]
  ds_read_b64 v[176:177], v3 offset:1664
  v_mfma_f32_16x16x32_bf16 v[48:51], v[72:75], v[104:107], v[48:51]
  ds_read_b64 v[178:179], v3 offset:1672
  v_mfma_f32_16x16x32_bf16 v[52:55], v[76:79], v[104:107], v[52:55]
  ds_read_b64 v[180:181], v3 offset:1152
  v_mfma_f32_16x16x32_bf16 v[56:59], v[80:83], v[104:107], v[56:59]
  ds_read_b64 v[182:183], v3 offset:1160
  v_mfma_f32_16x16x32_bf16 v[60:63], v[84:87], v[104:107], v[60:63]
  ds_read_b64 v[184:185], v3 offset:640
  v_mfma_f32_16x16x32_bf16 v[44:47], v[64:67], v[108:111], v[44:47]
  ds_read_b64 v[186:187], v3 offset:648
  v_mfma_f32_16x16x32_bf16 v[48:51], v[68:71], v[108:111], v[48:51]
  ds_read_b64 v[188:189], v3 offset:128
  v_mfma_f32_16x16x32_bf16 v[52:55], v[72:75], v[108:111], v[52:55]
  ds_read_b64 v[190:191], v3 offset:136
  v_mfma_f32_16x16x32_bf16 v[56:59], v[76:79], v[108:111], v[56:59]
  v_mfma_f32_16x16x32_bf16 v[60:63], v[80:83], v[108:111], v[60:63]
  s_waitcnt lgkmcnt(15)
  v_mfma_f32_16x16x32_bf16 v[48:51], v[64:67], v[112:115], v[48:51]
  v_mfma_f32_16x16x32_bf16 v[52:55], v[68:71], v[112:115], v[52:55]
  v_mfma_f32_16x16x32_bf16 v[56:59], v[72:75], v[112:115], v[56:59]
  v_mfma_f32_16x16x32_bf16 v[60:63], v[76:79], v[112:115], v[60:63]
  v_mfma_f32_16x16x32_bf16 v[52:55], v[64:67], v[116:119], v[52:55]
  v_mfma_f32_16x16x32_bf16 v[56:59], v[68:71], v[116:119], v[56:59]
  v_mfma_f32_16x16x32_bf16 v[60:63], v[72:75], v[116:119], v[60:63]
  v_mfma_f32_16x16x32_bf16 v[56:59], v[64:67], v[120:123], v[56:59]
  v_mfma_f32_16x16x32_bf16 v[60:63], v[68:71], v[120:123], v[60:63]
  v_mfma_f32_16x16x32_bf16 v[60:63], v[64:67], v[124:127], v[60:63]
  v_mfma_f32_16x16x32_bf16 v[32:35], v[128:131], v[160:163], v[32:35]
  ds_read_b64 v[96:97], v3 offset:3648
  v_mfma_f32_16x16x32_bf16 v[36:39], v[132:135], v[160:163], v[36:39]
  ds_read_b64 v[98:99], v3 offset:3656
  v_mfma_f32_16x16x32_bf16 v[40:43], v[136:139], v[160:163], v[40:43]
  ds_read_b128 v[64:67], v2 offset:64
  v_mfma_f32_16x16x32_bf16 v[44:47], v[140:143], v[160:163], v[44:47]
  ds_read_b128 v[68:71], v2 offset:576
  v_mfma_f32_16x16x32_bf16 v[48:51], v[144:147], v[160:163], v[48:51]
  ds_read_b128 v[72:75], v2 offset:1088
  v_mfma_f32_16x16x32_bf16 v[52:55], v[148:151], v[160:163], v[52:55]
  ds_read_b128 v[76:79], v2 offset:1600
  v_mfma_f32_16x16x32_bf16 v[56:59], v[152:155], v[160:163], v[56:59]
  ds_read_b128 v[80:83], v2 offset:2112
  s_waitcnt lgkmcnt(15)
  v_mfma_f32_16x16x32_bf16 v[60:63], v[156:159], v[160:163], v[60:63]
  ds_read_b128 v[84:87], v2 offset:2624
  v_mfma_f32_16x16x32_bf16 v[36:39], v[128:131], v[164:167], v[36:39]
  ds_read_b128 v[88:91], v2 offset:3136
  v_mfma_f32_16x16x32_bf16 v[40:43], v[132:135], v[164:167], v[40:43]
  ds_read_b128 v[92:95], v2 offset:3648
  v_mfma_f32_16x16x32_bf16 v[44:47], v[136:139], v[164:167], v[44:47]
  ds_read_b64 v[100:101], v3 offset:3136
  v_mfma_f32_16x16x32_bf16 v[48:51], v[140:143], v[164:167], v[48:51]
  ds_read_b64 v[102:103], v3 offset:3144
  v_mfma_f32_16x16x32_bf16 v[52:55], v[144:147], v[164:167], v[52:55]
  ds_read_b64 v[104:105], v3 offset:2624
  v_mfma_f32_16x16x32_bf16 v[56:59], v[148:151], v[164:167], v[56:59]
  ds_read_b64 v[106:107], v3 offset:2632
  v_mfma_f32_16x16x32_bf16 v[60:63], v[152:155], v[164:167], v[60:63]
  ds_read_b64 v[108:109], v3 offset:2112
  v_mfma_f32_16x16x32_bf16 v[40:43], v[128:131], v[168:171], v[40:43]
  ds_read_b64 v[110:111], v3 offset:2120
  v_mfma_f32_16x16x32_bf16 v[44:47], v[132:135], v[168:171], v[44:47]
  ds_read_b64 v[112:113], v3 offset:1600
  v_mfma_f32_16x16x32_bf16 v[48:51], v[136:139], v[168:171], v[48:51]
  ds_read_b64 v[114:115], v3 offset:1608
  v_mfma_f32_16x16x32_bf16 v[52:55], v[140:143], v[168:171], v[52:55]
  ds_read_b64 v[116:117], v3 offset:1088
  v_mfma_f32_16x16x32_bf16 v[56:59], v[144:147], v[168:171], v[56:59]
  ds_read_b64 v[118:119], v3 offset:1096
  v_mfma_f32_16x16x32_bf16 v[60:63], v[148:151], v[168:171], v[60:63]
  ds_read_b64 v[120:121], v3 offset:576
  v_mfma_f32_16x16x32_bf16 v[44:47], v[128:131], v[172:175], v[44:47]
  ds_read_b64 v[122:123], v3 offset:584
  v_mfma_f32_16x16x32_bf16 v[48:51], v[132:135], v[172:175], v[48:51]
  ds_read_b64 v[124:125], v3 offset:64
  v_mfma_f32_16x16x32_bf16 v[52:55], v[136:139], v[172:175], v[52:55]
  ds_read_b64 v[126:127], v3 offset:72
  v_mfma_f32_16x16x32_bf16 v[56:59], v[140:143], v[172:175], v[56:59]
  v_mfma_f32_16x16x32_bf16 v[60:63], v[144:147], v[172:175], v[60:63]
  s_waitcnt lgkmcnt(15)
  v_mfma_f32_16x16x32_bf16 v[48:51], v[128:131], v[176:179], v[48:51]
  v_mfma_f32_16x16x32_bf16 v[52:55], v[132:135], v[176:179], v[52:55]
  v_mfma_f32_16x16x32_bf16 v[56:59], v[136:139], v[176:179], v[56:59]
  v_mfma_f32_16x16x32_bf16 v[60:63], v[140:143], v[176:179], v[60:63]
  v_mfma_f32_16x16x32_bf16 v[52:55], v[128:131], v[180:183], v[52:55]
  v_mfma_f32_16x16x32_bf16 v[56:59], v[132:135], v[180:183], v[56:59]
  v_mfma_f32_16x16x32_bf16 v[60:63], v[136:139], v[180:183], v[60:63]
  v_mfma_f32_16x16x32_bf16 v[56:59], v[128:131], v[184:187], v[56:59]
  v_mfma_f32_16x16x32_bf16 v[60:63], v[132:135], v[184:187], v[60:63]
  v_mfma_f32_16x16x32_bf16 v[60:63], v[128:131], v[188:191], v[60:63]
  v_mfma_f32_16x16x32_bf16 v[32:35], v[64:67], v[96:99], v[32:35]
  ds_read_b64 v[160:161], v3 offset:3584
  v_mfma_f32_16x16x32_bf16 v[36:39], v[68:71], v[96:99], v[36:39]
  ds_read_b64 v[162:163], v3 offset:3592
  v_mfma_f32_16x16x32_bf16 v[40:43], v[72:75], v[96:99], v[40:43]
  ds_read_b128 v[128:131], v2 offset:0
  v_mfma_f32_16x16x32_bf16 v[44:47], v[76:79], v[96:99], v[44:47]
  ds_read_b128 v[132:135], v2 offset:512
  v_mfma_f32_16x16x32_bf16 v[48:51], v[80:83], v[96:99], v[48:51]
  ds_read_b128 v[136:139], v2 offset:1024
  v_mfma_f32_16x16x32_bf16 v[52:55], v[84:87], v[96:99], v[52:55]
  ds_read_b128 v[140:143], v2 offset:1536
  v_mfma_f32_16x16x32_bf16 v[56:59], v[88:91], v[96:99], v[56:59]
  ds_read_b128 v[144:147], v2 offset:2048
  s_waitcnt lgkmcnt(15)
  v_mfma_f32_16x16x32_bf16 v[60:63], v[92:95], v[96:99], v[60:63]
  ds_read_b128 v[148:151], v2 offset:2560
  v_mfma_f32_16x16x32_bf16 v[36:39], v[64:67], v[100:103], v[36:39]
  ds_read_b128 v[152:155], v2 offset:3072
  v_mfma_f32_16x16x32_bf16 v[40:43], v[68:71], v[100:103], v[40:43]
  ds_read_b128 v[156:159], v2 offset:3584
  v_mfma_f32_16x16x32_bf16 v[44:47], v[72:75], v[100:103], v[44:47]
  ds_read_b64 v[164:165], v3 offset:3072
  v_mfma_f32_16x16x32_bf16 v[48:51], v[76:79], v[100:103], v[48:51]
  ds_read_b64 v[166:167], v3 offset:3080
  v_mfma_f32_16x16x32_bf16 v[52:55], v[80:83], v[100:103], v[52:55]
  ds_read_b64 v[168:169], v3 offset:2560
  v_mfma_f32_16x16x32_bf16 v[56:59], v[84:87], v[100:103], v[56:59]
  ds_read_b64 v[170:171], v3 offset:2568
  v_mfma_f32_16x16x32_bf16 v[60:63], v[88:91], v[100:103], v[60:63]
  ds_read_b64 v[172:173], v3 offset:2048
  v_mfma_f32_16x16x32_bf16 v[40:43], v[64:67], v[104:107], v[40:43]
  ds_read_b64 v[174:175], v3 offset:2056
  v_mfma_f32_16x16x32_bf16 v[44:47], v[68:71], v[104:107], v[44:47]
  ds_read_b64 v[176:177], v3 offset:1536
  v_mfma_f32_16x16x32_bf16 v[48:51], v[72:75], v[104:107], v[48:51]
  ds_read_b64 v[178:179], v3 offset:1544
  v_mfma_f32_16x16x32_bf16 v[52:55], v[76:79], v[104:107], v[52:55]
  ds_read_b64 v[180:181], v3 offset:1024
  v_mfma_f32_16x16x32_bf16 v[56:59], v[80:83], v[104:107], v[56:59]
  ds_read_b64 v[182:183], v3 offset:1032
  v_mfma_f32_16x16x32_bf16 v[60:63], v[84:87], v[104:107], v[60:63]
  ds_read_b64 v[184:185], v3 offset:512
  v_mfma_f32_16x16x32_bf16 v[44:47], v[64:67], v[108:111], v[44:47]
  ds_read_b64 v[186:187], v3 offset:520
  v_mfma_f32_16x16x32_bf16 v[48:51], v[68:71], v[108:111], v[48:51]
  ds_read_b64 v[188:189], v3 offset:0
  v_mfma_f32_16x16x32_bf16 v[52:55], v[72:75], v[108:111], v[52:55]
  ds_read_b64 v[190:191], v3 offset:8
  v_mfma_f32_16x16x32_bf16 v[56:59], v[76:79], v[108:111], v[56:59]
  v_mfma_f32_16x16x32_bf16 v[60:63], v[80:83], v[108:111], v[60:63]
  s_waitcnt lgkmcnt(15)
  v_mfma_f32_16x16x32_bf16 v[48:51], v[64:67], v[112:115], v[48:51]
  v_mfma_f32_16x16x32_bf16 v[52:55], v[68:71], v[112:115], v[52:55]
  v_mfma_f32_16x16x32_bf16 v[56:59], v[72:75], v[112:115], v[56:59]
  v_mfma_f32_16x16x32_bf16 v[60:63], v[76:79], v[112:115], v[60:63]
  v_mfma_f32_16x16x32_bf16 v[52:55], v[64:67], v[116:119], v[52:55]
  v_mfma_f32_16x16x32_bf16 v[56:59], v[68:71], v[116:119], v[56:59]
  v_mfma_f32_16x16x32_bf16 v[60:63], v[72:75], v[116:119], v[60:63]
  v_mfma_f32_16x16x32_bf16 v[56:59], v[64:67], v[120:123], v[56:59]
  v_mfma_f32_16x16x32_bf16 v[60:63], v[68:71], v[120:123], v[60:63]
  v_mfma_f32_16x16x32_bf16 v[60:63], v[64:67], v[124:127], v[60:63]
  s_waitcnt lgkmcnt(0)
  ds_write_b32 v9, v11
  v_mfma_f32_16x16x32_bf16 v[32:35], v[128:131], v[160:163], v[32:35]
  v_mfma_f32_16x16x32_bf16 v[36:39], v[132:135], v[160:163], v[36:39]
  v_mfma_f32_16x16x32_bf16 v[40:43], v[136:139], v[160:163], v[40:43]
  v_mfma_f32_16x16x32_bf16 v[44:47], v[140:143], v[160:163], v[44:47]
  v_mfma_f32_16x16x32_bf16 v[48:51], v[144:147], v[160:163], v[48:51]
  v_mfma_f32_16x16x32_bf16 v[52:55], v[148:151], v[160:163], v[52:55]
  v_mfma_f32_16x16x32_bf16 v[56:59], v[152:155], v[160:163], v[56:59]
  v_mfma_f32_16x16x32_bf16 v[60:63], v[156:159], v[160:163], v[60:63]
  v_mfma_f32_16x16x32_bf16 v[36:39], v[128:131], v[164:167], v[36:39]
  v_mfma_f32_16x16x32_bf16 v[40:43], v[132:135], v[164:167], v[40:43]
  v_mfma_f32_16x16x32_bf16 v[44:47], v[136:139], v[164:167], v[44:47]
  v_mfma_f32_16x16x32_bf16 v[48:51], v[140:143], v[164:167], v[48:51]
  v_mfma_f32_16x16x32_bf16 v[52:55], v[144:147], v[164:167], v[52:55]
  v_mfma_f32_16x16x32_bf16 v[56:59], v[148:151], v[164:167], v[56:59]
  v_mfma_f32_16x16x32_bf16 v[60:63], v[152:155], v[164:167], v[60:63]
  v_mfma_f32_16x16x32_bf16 v[40:43], v[128:131], v[168:171], v[40:43]
  v_mfma_f32_16x16x32_bf16 v[44:47], v[132:135], v[168:171], v[44:47]
  v_mfma_f32_16x16x32_bf16 v[48:51], v[136:139], v[168:171], v[48:51]
  v_mfma_f32_16x16x32_bf16 v[52:55], v[140:143], v[168:171], v[52:55]
  v_mfma_f32_16x16x32_bf16 v[56:59], v[144:147], v[168:171], v[56:59]
  v_mfma_f32_16x16x32_bf16 v[60:63], v[148:151], v[168:171], v[60:63]
  v_mfma_f32_16x16x32_bf16 v[44:47], v[128:131], v[172:175], v[44:47]
  v_mfma_f32_16x16x32_bf16 v[48:51], v[132:135], v[172:175], v[48:51]
  v_mfma_f32_16x16x32_bf16 v[52:55], v[136:139], v[172:175], v[52:55]
  v_mfma_f32_16x16x32_bf16 v[56:59], v[140:143], v[172:175], v[56:59]
  v_mfma_f32_16x16x32_bf16 v[60:63], v[144:147], v[172:175], v[60:63]
  v_mfma_f32_16x16x32_bf16 v[48:51], v[128:131], v[176:179], v[48:51]
  v_mfma_f32_16x16x32_bf16 v[52:55], v[132:135], v[176:179], v[52:55]
  v_mfma_f32_16x16x32_bf16 v[56:59], v[136:139], v[176:179], v[56:59]
  v_mfma_f32_16x16x32_bf16 v[60:63], v[140:143], v[176:179], v[60:63]
  v_mfma_f32_16x16x32_bf16 v[52:55], v[128:131], v[180:183], v[52:55]
  v_mfma_f32_16x16x32_bf16 v[56:59], v[132:135], v[180:183], v[56:59]
  v_mfma_f32_16x16x32_bf16 v[60:63], v[136:139], v[180:183], v[60:63]
  v_mfma_f32_16x16x32_bf16 v[56:59], v[128:131], v[184:187], v[56:59]
  v_mfma_f32_16x16x32_bf16 v[60:63], v[132:135], v[184:187], v[60:63]
  v_mfma_f32_16x16x32_bf16 v[60:63], v[128:131], v[188:191], v[60:63]
  v_lshlrev_b32 v12, 7, v5
  v_lshl_add_u32 v12, v4, 2, v12
  s_lshl_b32 s70, s77, 11
  s_add_u32 s70, s70, s80
  v_add_u32 v12, s70, v12
  v_lshl_add_u32 v15, v1, 4, s70
  ds_read_b32 v64, v12 offset:13536
  ds_read_b32 v65, v12 offset:13600
  ds_read_b32 v66, v12 offset:14048
  ds_read_b32 v67, v12 offset:14112
  ds_read_b32 v68, v12 offset:14560
  ds_read_b32 v69, v12 offset:14624
  ds_read_b32 v70, v12 offset:15072
  ds_read_b32 v71, v12 offset:15136
  s_lshl_b32 s70, s77, 12
  s_add_u32 s71, s70, s80
  v_lshl_add_u32 v13, v1, 4, s71
  s_xor_b32 s70, s70, 4096
  s_add_u32 s71, s70, s80
  v_lshl_add_u32 v14, v1, 4, s71
  s_waitcnt lgkmcnt(0)
  s_mov_b32 s69, 131072
Lp13:
  ds_read_b32 v16, v10
  s_waitcnt lgkmcnt(0)
  v_cmp_eq_u32 vcc, 0, v16
  s_cbranch_vccz Lk14
  s_sub_u32 s69, s69, 1
  s_cbranch_scc0 Lp13
Lk14:
  s_nop 0
  s_nop 0
  s_nop 7
  s_cmp_eq_u32 s77, 0
  s_cbranch_scc0 Lx15
  ds_write_b128 v13, v[48:51] offset:0
  ds_write_b128 v13, v[52:55] offset:1024
  ds_write_b128 v13, v[56:59] offset:2048
  ds_write_b128 v13, v[60:63] offset:3072
  s_branch Lx16
Lx15:
  ds_write_b128 v13, v[32:35] offset:0
  ds_write_b128 v13, v[36:39] offset:1024
  ds_write_b128 v13, v[40:43] offset:2048
  ds_write_b128 v13, v[44:47] offset:3072
  s_waitcnt lgkmcnt(0)
  v_mov_b32 v32, v48
  v_mov_b32 v33, v49
  v_mov_b32 v34, v50
  v_mov_b32 v35, v51
  v_mov_b32 v36, v52
  v_mov_b32 v37, v53
  v_mov_b32 v38, v54
  v_mov_b32 v39, v55
  v_mov_b32 v40, v56
  v_mov_b32 v41, v57
  v_mov_b32 v42, v58
  v_mov_b32 v43, v59
  v_mov_b32 v44, v60
  v_mov_b32 v45, v61
  v_mov_b32 v46, v62
  v_mov_b32 v47, v63
Lx16:
  s_waitcnt lgkmcnt(0)
  ds_write_b32 v9, v11 offset:16
  v_lshlrev_b32 v72, 16, v64
  v_and_b32 v73, 0xffff0000, v64
  v_lshlrev_b32 v74, 16, v65
  v_and_b32 v75, 0xffff0000, v65
  v_lshlrev_b32 v76, 16, v66
  v_and_b32 v77, 0xffff0000, v66
  v_lshlrev_b32 v78, 16, v67
  v_and_b32 v79, 0xffff0000, v67
  v_lshlrev_b32 v80, 16, v68
  v_and_b32 v81, 0xffff0000, v68
  v_lshlrev_b32 v82, 16, v69
  v_and_b32 v83, 0xffff0000, v69
  v_lshlrev_b32 v84, 16, v70
  v_and_b32 v85, 0xffff0000, v70
  v_lshlrev_b32 v86, 16, v71
  v_and_b32 v87, 0xffff0000, v71
  v_fmac_f32 v32, s78, v72
  v_fmac_f32 v33, s78, v73
  v_fmac_f32 v34, s78, v74
  v_fmac_f32 v35, s78, v75
  v_fmac_f32 v36, s78, v76
  v_fmac_f32 v37, s78, v77
  v_fmac_f32 v38, s78, v78
  v_fmac_f32 v39, s78, v79
  v_fmac_f32 v40, s78, v80
  v_fmac_f32 v41, s78, v81
  v_fmac_f32 v42, s78, v82
  v_fmac_f32 v43, s78, v83
  v_fmac_f32 v44, s78, v84
  v_fmac_f32 v45, s78, v85
  v_fmac_f32 v46, s78, v86
  v_fmac_f32 v47, s78, v87
  s_waitcnt lgkmcnt(0)
  s_mov_b32 s69, 131072
Lp17:
  ds_read_b32 v16, v10 offset:16
  s_waitcnt lgkmcnt(0)
  v_cmp_eq_u32 vcc, 0, v16
  s_cbranch_vccz Lk18
  s_sub_u32 s69, s69, 1
  s_cbranch_scc0 Lp17
Lk18:
  s_nop 0
  s_nop 0
  ds_read_b128 v[48:51], v14 offset:0
  ds_read_b128 v[52:55], v14 offset:1024
  ds_read_b128 v[56:59], v14 offset:2048
  ds_read_b128 v[60:63], v14 offset:3072
  s_waitcnt lgkmcnt(3)
  v_add_f32 v32, v32, v48
  v_add_f32 v33, v33, v49
  v_add_f32 v34, v34, v50
  v_add_f32 v35, v35, v51
  s_waitcnt lgkmcnt(2)
  v_add_f32 v36, v36, v52
  v_add_f32 v37, v37, v53
  v_add_f32 v38, v38, v54
  v_add_f32 v39, v39, v55
  s_waitcnt lgkmcnt(1)
  v_add_f32 v40, v40, v56
  v_add_f32 v41, v41, v57
  v_add_f32 v42, v42, v58
  v_add_f32 v43, v43, v59
  s_waitcnt lgkmcnt(0)
  v_add_f32 v44, v44, v60
  v_add_f32 v45, v45, v61
  v_add_f32 v46, v46, v62
  v_add_f32 v47, v47, v63
  v_cvt_pk_bf16_f32 v64, v32, v33
  ds_write_b32 v12, v64 offset:8448
  v_cvt_pk_bf16_f32 v65, v34, v35
  ds_write_b32 v12, v65 offset:8512
  v_cvt_pk_bf16_f32 v66, v36, v37
  ds_write_b32 v12, v66 offset:8960
  v_cvt_pk_bf16_f32 v67, v38, v39
  ds_write_b32 v12, v67 offset:9024
  v_cvt_pk_bf16_f32 v68, v40, v41
  ds_write_b32 v12, v68 offset:9472
  v_cvt_pk_bf16_f32 v69, v42, v43
  ds_write_b32 v12, v69 offset:9536
  v_cvt_pk_bf16_f32 v70, v44, v45
  ds_write_b32 v12, v70 offset:9984
  v_cvt_pk_bf16_f32 v71, v46, v47
  ds_write_b32 v12, v71 offset:10048
  ds_read_b128 v[72:75], v15 offset:8448
  ds_read_b128 v[76:79], v15 offset:9472
  s_lshl_b32 s70, s79, 12
  s_lshl_b32 s71, s77, 11
  s_add_u32 s70, s70, s71
  s_add_u32 s70, s70, 9437184
  v_lshlrev_b32 v15, 4, v1
  s_waitcnt lgkmcnt(1)
  buffer_store_dwordx4 v[72:75], v15, s[56:59], s70 offen offset:0 sc1
  s_waitcnt lgkmcnt(0)
  buffer_store_dwordx4 v[76:79], v15, s[56:59], s70 offen offset:1024 sc1
  s_lshr_b32 s82, s79, 4
  s_lshl_b32 s70, s77, 5
  s_add_u32 s82, s82, s70
  s_lshl_b32 s82, s82, 8
  s_add_u32 s82, s82, 11583488
  v_mov_b32 v16, 1
  s_lshr_b32 s83, s39, 4
  s_lshl_b32 s83, s83, 3
  s_add_u32 s83, s83, s38
  s_lshl_b32 s83, s83, 2
  s_add_u32 s83, s83, s75
  s_lshl_b32 s83, s83, 8
  s_add_u32 s83, s83, 11583488
  v_lshrrev_b32 v19, 3, v1
  v_and_b32 v20, 7, v1
  v_lshlrev_b32 v20, 4, v20
  v_lshl_add_u32 v21, v19, 12, v20
  v_mul_u32_u24 v19, 160, v19
  s_mul_i32 s70, s75, 2560
  s_add_u32 s70, s70, 151552
  v_add3_u32 v22, v19, v20, s70
  s_lshl_b32 s84, s38, 18
  s_lshl_b32 s70, s75, 16
  s_add_u32 s84, s84, s70
  s_lshl_b32 s70, s39, 7
  s_add_u32 s84, s84, s70
  s_add_u32 s84, s84, 9437184
  s_add_u32 s85, s84, 0x8000
  s_waitcnt vmcnt(0)
  s_mov_b64 exec, 1
  buffer_atomic_add v16, off, s[56:59], s82 sc1
  s_mov_b64 exec, -1
  s_and_b32 s70, s34, 3
  s_lshr_b32 s71, s34, 2
  v_and_b32 v6, 15, v1
  v_lshrrev_b32 v7, 4, v1
  s_lshl_b32 s75, s70, 4
  v_add_u32 v8, s75, v6
  s_lshr_b32 s76, s70, 1
  s_lshl_b32 s77, s71, 1
  s_add_u32 s76, s76, s77
  s_lshl_b32 s76, s76, 14
  v_and_b32 v2, 31, v8
  v_lshlrev_b32 v2, 4, v2
  v_lshl_add_u32 v2, v7, 10, v2
  v_add_u32 v2, s76, v2
  s_lshl_b32 s77, s71, 2
  v_add_u32 v9, s77, v7
  v_bfe_u32 v3, v1, 2, 2
  v_lshl_add_u32 v3, v9, 3, v3
  v_mul_u32_u24 v3, 160, v3
  v_and_b32 v4, 3, v1
  v_lshl_add_u32 v3, v4, 3, v3
  s_lshl_b32 s77, s70, 5
  s_add_u32 s77, s77, 151552
  v_add_u32 v3, s77, v3
  v_lshlrev_b32 v4, 3, v8
  v_add_u32 v4, 161792, v4
  v_lshlrev_b32 v5, 10, v8
  v_lshl_add_u32 v5, v9, 4, v5
  s_lshl_b32 s76, s39, 16
  s_lshl_b32 s77, s38, 7
  s_add_u32 s76, s76, s77
  s_bfm_b64 exec, 1, 0
  s_mov_b32 s69, 4096
Lp19:
  v_mov_b32 v18, 0
  buffer_atomic_or v18, off, s[56:59], s83 sc0 sc1
  s_waitcnt vmcnt(0)
  v_cmp_ne_u32 vcc, 16, v18
  s_cbranch_vccz Lk20
  s_sub_u32 s69, s69, 1
  s_cbranch_scc0 Lp19
Lk20:
  s_mov_b64 exec, -1
  s_nop 0
  buffer_load_dwordx4 v[24:27], v21, s[56:59], s84 offen sc1
  buffer_load_dwordx4 v[28:31], v21, s[56:59], s85 offen sc1
  s_waitcnt vmcnt(1)
  ds_write_b128 v22, v[24:27] offset:0
  s_waitcnt vmcnt(0)
  ds_write_b128 v22, v[28:31] offset:1280
  s_waitcnt lgkmcnt(0)
  s_barrier
  s_branch LF
LAaux:
  s_lshl_b32 s70, s75, 9
  s_sub_u32 s70, 2047, s70
  v_lshlrev_b32 v104, 3, v1
  v_sub_u32 v104, s70, v104
  v_cvt_f32_u32 v105, v104
  s_mov_b32 s82, 151584
  s_movk_i32 s83, 128
  v_add_f32 v106, 0x80000000, v105
  v_add_f32 v107, 0xbf800000, v105
  v_cvt_pk_bf16_f32 v106, v106, v107
  v_ashrrev_i32 v107, 16, v106
  v_bfe_i32 v106, v106, 0, 16
  v_subrev_u32 v106, 17024, v106
  v_subrev_u32 v108, 0, v104
  v_med3_i32 v106, v106, v108, s83
  v_max_i32 v108, 0, v106
  v_lshrrev_b32 v108, 3, v108
  v_add_u32 v108, v106, v108
  v_lshl_add_u32 v110, v108, 4, s82
  v_subrev_u32 v107, 17024, v107
  v_subrev_u32 v108, 1, v104
  v_med3_i32 v107, v107, v108, s83
  v_max_i32 v108, 0, v107
  v_lshrrev_b32 v108, 3, v108
  v_add_u32 v108, v107, v108
  v_lshl_add_u32 v111, v108, 4, s82
  v_add_f32 v106, 0xc0000000, v105
  v_add_f32 v107, 0xc0400000, v105
  v_cvt_pk_bf16_f32 v106, v106, v107
  v_ashrrev_i32 v107, 16, v106
  v_bfe_i32 v106, v106, 0, 16
  v_subrev_u32 v106, 17024, v106
  v_subrev_u32 v108, 2, v104
  v_med3_i32 v106, v106, v108, s83
  v_max_i32 v108, 0, v106
  v_lshrrev_b32 v108, 3, v108
  v_add_u32 v108, v106, v108
  v_lshl_add_u32 v112, v108, 4, s82
  v_subrev_u32 v107, 17024, v107
  v_subrev_u32 v108, 3, v104
  v_med3_i32 v107, v107, v108, s83
  v_max_i32 v108, 0, v107
  v_lshrrev_b32 v108, 3, v108
  v_add_u32 v108, v107, v108
  v_lshl_add_u32 v113, v108, 4, s82
  v_add_f32 v106, 0xc0800000, v105
  v_add_f32 v107, 0xc0a00000, v105
  v_cvt_pk_bf16_f32 v106, v106, v107
  v_ashrrev_i32 v107, 16, v106
  v_bfe_i32 v106, v106, 0, 16
  v_subrev_u32 v106, 17024, v106
  v_subrev_u32 v108, 4, v104
  v_med3_i32 v106, v106, v108, s83
  v_max_i32 v108, 0, v106
  v_lshrrev_b32 v108, 3, v108
  v_add_u32 v108, v106, v108
  v_lshl_add_u32 v114, v108, 4, s82
  v_subrev_u32 v107, 17024, v107
  v_subrev_u32 v108, 5, v104
  v_med3_i32 v107, v107, v108, s83
  v_max_i32 v108, 0, v107
  v_lshrrev_b32 v108, 3, v108
  v_add_u32 v108, v107, v108
  v_lshl_add_u32 v115, v108, 4, s82
  v_add_f32 v106, 0xc0c00000, v105
  v_add_f32 v107, 0xc0e00000, v105
  v_cvt_pk_bf16_f32 v106, v106, v107
  v_ashrrev_i32 v107, 16, v106
  v_bfe_i32 v106, v106, 0, 16
  v_subrev_u32 v106, 17024, v106
  v_subrev_u32 v108, 6, v104
  v_med3_i32 v106, v106, v108, s83
  v_max_i32 v108, 0, v106
  v_lshrrev_b32 v108, 3, v108
  v_add_u32 v108, v106, v108
  v_lshl_add_u32 v116, v108, 4, s82
  v_subrev_u32 v107, 17024, v107
  v_subrev_u32 v108, 7, v104
  v_med3_i32 v107, v107, v108, s83
  v_max_i32 v108, 0, v107
  v_lshrrev_b32 v108, 3, v108
  v_add_u32 v108, v107, v108
  v_lshl_add_u32 v117, v108, 4, s82
  v_add_f32 v106, 0xc1000000, v105
  v_add_f32 v107, 0xc1100000, v105
  v_cvt_pk_bf16_f32 v106, v106, v107
  v_ashrrev_i32 v107, 16, v106
  v_bfe_i32 v106, v106, 0, 16
  v_subrev_u32 v106, 17024, v106
  v_subrev_u32 v108, 8, v104
  v_med3_i32 v106, v106, v108, s83
  v_max_i32 v108, 0, v106
  v_lshrrev_b32 v108, 3, v108
  v_add_u32 v108, v106, v108
  v_lshl_add_u32 v118, v108, 4, s82
  v_subrev_u32 v107, 17024, v107
  v_subrev_u32 v108, 9, v104
  v_med3_i32 v107, v107, v108, s83
  v_max_i32 v108, 0, v107
  v_lshrrev_b32 v108, 3, v108
  v_add_u32 v108, v107, v108
  v_lshl_add_u32 v119, v108, 4, s82
  s_waitcnt lgkmcnt(0)
  s_lshl_b32 s70, s81, 16
  s_and_b32 s71, s81, 0xffff0000
  s_cmp_eq_u32 s76, 0
  s_cselect_b32 s81, s70, s71
  s_lshl_b32 s70, s78, 16
  s_and_b32 s71, s78, 0xffff0000
  s_cmp_eq_u32 s76, 0
  s_cselect_b32 s78, s70, s71
  s_mul_i32 s70, s75, 9216
  s_add_u32 s70, s70, 114688
  v_mul_u32_u24 v21, 144, v1
  v_add_u32 v21, s70, v21
  v_bfe_u32 v24, v1, 3, 2
  v_lshrrev_b32 v25, 5, v1
  v_lshlrev_b32 v25, 1, v25
  v_lshl_add_u32 v24, v24, 2, v25
  v_mul_u32_u24 v24, 144, v24
  v_bfe_u32 v25, v1, 2, 1
  v_lshl_add_u32 v24, v25, 5, v24
  v_add_u32 v22, s70, v24
  v_lshlrev_b32 v25, 3, v1
  v_and_b32 v25, 24, v25
  v_add_u32 v2, v22, v25
  s_lshl_b32 s82, s75, 2
  s_add_u32 s82, s82, 151584
  v_lshrrev_b32 v23, 4, v1
  v_and_b32 v24, 7, v1
  v_bfe_u32 v25, v1, 3, 1
  v_mul_u32_u24 v27, 144, v25
  v_add_u32 v27, v27, v24
  v_mad_u32_u24 v27, v23, 36, v27
  v_lshl_add_u32 v27, v27, 4, s82
  v_lshlrev_b32 v28, 2, v25
  v_xor_b32 v6, v27, v28
  v_and_b32 v27, 15, v1
  v_mul_u32_u24 v27, 18, v27
  v_lshl_add_u32 v27, v23, 2, v27
  v_lshrrev_b32 v28, 1, v23
  v_add_u32 v27, v27, v28
  v_lshl_add_u32 v27, v27, 4, s82
  v_and_b32 v28, 1, v1
  v_lshlrev_b32 v28, 2, v28
  v_xor_b32 v7, v27, v28
  v_sub_u32 v27, 2, v25
  v_lshrrev_b32 v28, v27, v24
  v_lshlrev_b32 v29, 4, v28
  v_lshl_add_u32 v29, v23, 2, v29
  v_lshlrev_b32 v29, v27, v29
  v_bfe_u32 v30, v24, 0, v27
  v_add_u32 v29, v29, v30
  v_lshl_add_u32 v29, v25, 7, v29
  v_and_b32 v28, 1, v28
  v_lshlrev_b32 v28, 2, v28
  v_lshlrev_b32 v27, v27, 1
  v_lshrrev_b32 v30, 3, v29
  v_add_u32 v30, v29, v30
  v_lshl_add_u32 v30, v30, 4, s82
  v_xor_b32 v3, v30, v28
  v_add_u32 v29, v29, v27
  v_lshrrev_b32 v30, 3, v29
  v_add_u32 v30, v29, v30
  v_lshl_add_u32 v30, v30, 4, s82
  v_xor_b32 v4, v30, v28
  v_add_u32 v29, v29, v27
  v_lshrrev_b32 v30, 3, v29
  v_add_u32 v30, v29, v30
  v_lshl_add_u32 v30, v30, 4, s82
  v_xor_b32 v5, v30, v28
  v_add_u32 v29, v29, v27
  v_lshrrev_b32 v30, 3, v29
  v_add_u32 v30, v29, v30
  v_lshl_add_u32 v30, v30, 4, s82
  v_xor_b32 v8, v30, v28
  v_mov_b32 v26, s81
  v_mul_f32 v26, 1069066811, v26
  v_exp_f32 v26, v26
  s_nop 0
  v_cvt_pk_bf16_f32 v26, v26, v26
  v_and_b32 v26, 0xffff0000, v26
  s_waitcnt vmcnt(5)
  v_lshlrev_b32 v16, 16, v16
  s_waitcnt vmcnt(4)
  v_lshlrev_b32 v17, 16, v17
  s_waitcnt vmcnt(3)
  v_lshlrev_b32 v18, 16, v18
  s_waitcnt vmcnt(2)
  v_lshlrev_b32 v19, 16, v19
  v_mul_f32 v16, 1069066811, v16
  v_exp_f32 v16, v16
  s_nop 0
  v_cvt_pk_bf16_f32 v16, v16, v16
  v_and_b32 v16, 0xffff0000, v16
  v_mul_f32 v16, v16, v26
  v_mul_f32 v17, v17, v26
  v_mul_f32 v18, v18, v26
  v_mul_f32 v19, v19, v26
  v_mul_f32 v16, 0xbfb8aa3b, v16
  v_mul_f32 v17, 0.15915494, v17
  v_add_f32 v160, v18, v18
  v_add_f32 v161, v19, v19
  v_mul_f32 v52, 0x41000000, v16
  v_mul_f32 v53, 0x41000000, v17
  v_exp_f32 v52, v52
  v_fract_f32 v53, v53
  v_cos_f32 v130, v53
  v_sin_f32 v131, v53
  v_mul_f32 v130, v130, v52
  v_mul_f32 v131, v131, v52
  v_mul_f32 v52, 1.0, v16
  v_mul_f32 v53, 1.0, v17
  v_exp_f32 v52, v52
  v_fract_f32 v53, v53
  v_cos_f32 v120, v53
  v_sin_f32 v121, v53
  v_mul_f32 v120, v120, v52
  v_mul_f32 v121, v121, v52
  v_pk_mul_f32 v[52:53], v[130:131], v[130:131] op_sel:[1,1] op_sel_hi:[1,0] neg_lo:[1,0]
  v_pk_fma_f32 v[132:133], v[130:131], v[130:131], v[52:53] op_sel:[0,0,0] op_sel_hi:[0,1,1]
  v_pk_mul_f32 v[52:53], v[132:133], v[130:131] op_sel:[1,1] op_sel_hi:[1,0] neg_lo:[1,0]
  v_pk_fma_f32 v[134:135], v[132:133], v[130:131], v[52:53] op_sel:[0,0,0] op_sel_hi:[0,1,1]
  v_pk_mul_f32 v[52:53], v[132:133], v[132:133] op_sel:[1,1] op_sel_hi:[1,0] neg_lo:[1,0]
  v_pk_fma_f32 v[136:137], v[132:133], v[132:133], v[52:53] op_sel:[0,0,0] op_sel_hi:[0,1,1]
  v_pk_mul_f32 v[52:53], v[136:137], v[130:131] op_sel:[1,1] op_sel_hi:[1,0] neg_lo:[1,0]
  v_pk_fma_f32 v[138:139], v[136:137], v[130:131], v[52:53] op_sel:[0,0,0] op_sel_hi:[0,1,1]
  v_pk_mul_f32 v[52:53], v[136:137], v[132:133] op_sel:[1,1] op_sel_hi:[1,0] neg_lo:[1,0]
  v_pk_fma_f32 v[140:141], v[136:137], v[132:133], v[52:53] op_sel:[0,0,0] op_sel_hi:[0,1,1]
  v_pk_mul_f32 v[52:53], v[136:137], v[134:135] op_sel:[1,1] op_sel_hi:[1,0] neg_lo:[1,0]
  v_pk_fma_f32 v[142:143], v[136:137], v[134:135], v[52:53] op_sel:[0,0,0] op_sel_hi:[0,1,1]
  v_cvt_pk_bf16_f32 v36, 1.0, v130
  v_cvt_pk_bf16_f32 v37, v132, v134
  v_cvt_pk_bf16_f32 v38, v136, v138
  v_cvt_pk_bf16_f32 v39, v140, v142
  v_cvt_pk_bf16_f32 v40, 0, v131
  ds_write_b128 v21, v[36:39] offset:0
  v_cvt_pk_bf16_f32 v41, v133, v135
  v_cvt_pk_bf16_f32 v42, v137, v139
  v_cvt_pk_bf16_f32 v43, v141, v143
  v_pk_mul_f32 v[52:53], v[136:137], v[136:137] op_sel:[1,1] op_sel_hi:[1,0] neg_lo:[1,0]
  v_pk_fma_f32 v[144:145], v[136:137], v[136:137], v[52:53] op_sel:[0,0,0] op_sel_hi:[0,1,1]
  ds_write_b128 v21, v[40:43] offset:32
  v_pk_mul_f32 v[52:53], v[144:145], v[130:131] op_sel:[1,1] op_sel_hi:[1,0] neg_lo:[1,0]
  v_pk_fma_f32 v[146:147], v[144:145], v[130:131], v[52:53] op_sel:[0,0,0] op_sel_hi:[0,1,1]
  v_pk_mul_f32 v[52:53], v[144:145], v[132:133] op_sel:[1,1] op_sel_hi:[1,0] neg_lo:[1,0]
  v_pk_fma_f32 v[148:149], v[144:145], v[132:133], v[52:53] op_sel:[0,0,0] op_sel_hi:[0,1,1]
  v_pk_mul_f32 v[52:53], v[144:145], v[134:135] op_sel:[1,1] op_sel_hi:[1,0] neg_lo:[1,0]
  v_pk_fma_f32 v[150:151], v[144:145], v[134:135], v[52:53] op_sel:[0,0,0] op_sel_hi:[0,1,1]
  v_pk_mul_f32 v[52:53], v[144:145], v[136:137] op_sel:[1,1] op_sel_hi:[1,0] neg_lo:[1,0]
  v_pk_fma_f32 v[152:153], v[144:145], v[136:137], v[52:53] op_sel:[0,0,0] op_sel_hi:[0,1,1]
  v_pk_mul_f32 v[52:53], v[144:145], v[138:139] op_sel:[1,1] op_sel_hi:[1,0] neg_lo:[1,0]
  v_pk_fma_f32 v[154:155], v[144:145], v[138:139], v[52:53] op_sel:[0,0,0] op_sel_hi:[0,1,1]
  v_pk_mul_f32 v[52:53], v[144:145], v[140:141] op_sel:[1,1] op_sel_hi:[1,0] neg_lo:[1,0]
  v_pk_fma_f32 v[156:157], v[144:145], v[140:141], v[52:53] op_sel:[0,0,0] op_sel_hi:[0,1,1]
  v_pk_mul_f32 v[52:53], v[144:145], v[142:143] op_sel:[1,1] op_sel_hi:[1,0] neg_lo:[1,0]
  v_pk_fma_f32 v[158:159], v[144:145], v[142:143], v[52:53] op_sel:[0,0,0] op_sel_hi:[0,1,1]
  v_cvt_pk_bf16_f32 v44, v144, v146
  v_cvt_pk_bf16_f32 v45, v148, v150
  v_cvt_pk_bf16_f32 v46, v152, v154
  v_cvt_pk_bf16_f32 v47, v156, v158
  v_cvt_pk_bf16_f32 v48, v145, v147
  ds_write_b128 v21, v[44:47] offset:16
  v_cvt_pk_bf16_f32 v49, v149, v151
  v_cvt_pk_bf16_f32 v50, v153, v155
  v_cvt_pk_bf16_f32 v51, v157, v159
  v_pk_mul_f32 v[52:53], v[144:145], v[144:145] op_sel:[1,1] op_sel_hi:[1,0] neg_lo:[1,0]
  v_pk_fma_f32 v[122:123], v[144:145], v[144:145], v[52:53] op_sel:[0,0,0] op_sel_hi:[0,1,1]
  ds_write_b128 v21, v[48:51] offset:48
  ds_read_b64_tr_b16 v[64:65], v2 offset:0
  ds_read_b64_tr_b16 v[66:67], v2 offset:144
  ds_read_b64_tr_b16 v[68:69], v2 offset:2304
  ds_read_b64_tr_b16 v[70:71], v2 offset:2448
  ds_read_b64_tr_b16 v[72:73], v2 offset:4608
  ds_read_b64_tr_b16 v[74:75], v2 offset:4752
  ds_read_b64_tr_b16 v[76:77], v2 offset:6912
  ds_read_b64_tr_b16 v[78:79], v2 offset:7056
  v_pk_mul_f32 v[52:53], v[160:161], v[120:121] op_sel:[1,1] op_sel_hi:[1,0] neg_lo:[1,0]
  v_pk_fma_f32 v[162:163], v[160:161], v[120:121], v[52:53] op_sel:[0,0,0] op_sel_hi:[0,1,1]
  v_pk_mul_f32 v[52:53], v[162:163], v[120:121] op_sel:[1,1] op_sel_hi:[1,0] neg_lo:[1,0]
  v_pk_fma_f32 v[164:165], v[162:163], v[120:121], v[52:53] op_sel:[0,0,0] op_sel_hi:[0,1,1]
  v_pk_mul_f32 v[52:53], v[164:165], v[120:121] op_sel:[1,1] op_sel_hi:[1,0] neg_lo:[1,0]
  v_pk_fma_f32 v[166:167], v[164:165], v[120:121], v[52:53] op_sel:[0,0,0] op_sel_hi:[0,1,1]
  v_pk_mul_f32 v[52:53], v[166:167], v[120:121] op_sel:[1,1] op_sel_hi:[1,0] neg_lo:[1,0]
  v_pk_fma_f32 v[168:169], v[166:167], v[120:121], v[52:53] op_sel:[0,0,0] op_sel_hi:[0,1,1]
  v_pk_mul_f32 v[52:53], v[168:169], v[120:121] op_sel:[1,1] op_sel_hi:[1,0] neg_lo:[1,0]
  v_pk_fma_f32 v[170:171], v[168:169], v[120:121], v[52:53] op_sel:[0,0,0] op_sel_hi:[0,1,1]
  v_pk_mul_f32 v[52:53], v[170:171], v[120:121] op_sel:[1,1] op_sel_hi:[1,0] neg_lo:[1,0]
  v_pk_fma_f32 v[172:173], v[170:171], v[120:121], v[52:53] op_sel:[0,0,0] op_sel_hi:[0,1,1]
  v_pk_mul_f32 v[52:53], v[172:173], v[120:121] op_sel:[1,1] op_sel_hi:[1,0] neg_lo:[1,0]
  v_pk_fma_f32 v[174:175], v[172:173], v[120:121], v[52:53] op_sel:[0,0,0] op_sel_hi:[0,1,1]
  v_cvt_pk_bf16_f32 v96, v160, v162
  v_cvt_pk_bf16_f32 v97, v164, v166
  v_cvt_pk_bf16_f32 v98, v168, v170
  v_cvt_pk_bf16_f32 v99, v172, v174
  v_cvt_pk_bf16_f32 v100, -v161, -v163
  ds_write_b128 v21, v[96:99] offset:64
  v_cvt_pk_bf16_f32 v101, -v165, -v167
  v_cvt_pk_bf16_f32 v102, -v169, -v171
  v_cvt_pk_bf16_f32 v103, -v173, -v175
  v_pk_mul_f32 v[52:53], v[160:161], v[122:123] op_sel:[1,1] op_sel_hi:[1,0] neg_lo:[1,0]
  v_pk_fma_f32 v[176:177], v[160:161], v[122:123], v[52:53] op_sel:[0,0,0] op_sel_hi:[0,1,1]
  ds_write_b128 v21, v[100:103] offset:96
  v_pk_mul_f32 v[52:53], v[162:163], v[122:123] op_sel:[1,1] op_sel_hi:[1,0] neg_lo:[1,0]
  v_pk_fma_f32 v[178:179], v[162:163], v[122:123], v[52:53] op_sel:[0,0,0] op_sel_hi:[0,1,1]
  v_pk_mul_f32 v[52:53], v[164:165], v[122:123] op_sel:[1,1] op_sel_hi:[1,0] neg_lo:[1,0]
  v_pk_fma_f32 v[180:181], v[164:165], v[122:123], v[52:53] op_sel:[0,0,0] op_sel_hi:[0,1,1]
  v_pk_mul_f32 v[52:53], v[166:167], v[122:123] op_sel:[1,1] op_sel_hi:[1,0] neg_lo:[1,0]
  v_pk_fma_f32 v[182:183], v[166:167], v[122:123], v[52:53] op_sel:[0,0,0] op_sel_hi:[0,1,1]
  v_pk_mul_f32 v[52:53], v[168:169], v[122:123] op_sel:[1,1] op_sel_hi:[1,0] neg_lo:[1,0]
  v_pk_fma_f32 v[184:185], v[168:169], v[122:123], v[52:53] op_sel:[0,0,0] op_sel_hi:[0,1,1]
  v_pk_mul_f32 v[52:53], v[170:171], v[122:123] op_sel:[1,1] op_sel_hi:[1,0] neg_lo:[1,0]
  v_pk_fma_f32 v[186:187], v[170:171], v[122:123], v[52:53] op_sel:[0,0,0] op_sel_hi:[0,1,1]
  v_pk_mul_f32 v[52:53], v[172:173], v[122:123] op_sel:[1,1] op_sel_hi:[1,0] neg_lo:[1,0]
  v_pk_fma_f32 v[188:189], v[172:173], v[122:123], v[52:53] op_sel:[0,0,0] op_sel_hi:[0,1,1]
  v_pk_mul_f32 v[52:53], v[174:175], v[122:123] op_sel:[1,1] op_sel_hi:[1,0] neg_lo:[1,0]
  v_pk_fma_f32 v[190:191], v[174:175], v[122:123], v[52:53] op_sel:[0,0,0] op_sel_hi:[0,1,1]
  v_cvt_pk_bf16_f32 v212, v176, v178
  v_cvt_pk_bf16_f32 v213, v180, v182
  v_cvt_pk_bf16_f32 v214, v184, v186
  v_cvt_pk_bf16_f32 v215, v188, v190
  v_cvt_pk_bf16_f32 v216, -v177, -v179
  ds_write_b128 v21, v[212:215] offset:80
  v_cvt_pk_bf16_f32 v217, -v181, -v183
  v_cvt_pk_bf16_f32 v218, -v185, -v187
  v_cvt_pk_bf16_f32 v219, -v189, -v191
  v_pk_mul_f32 v[52:53], v[122:123], v[122:123] op_sel:[1,1] op_sel_hi:[1,0] neg_lo:[1,0]
  v_pk_fma_f32 v[124:125], v[122:123], v[122:123], v[52:53] op_sel:[0,0,0] op_sel_hi:[0,1,1]
  ds_write_b128 v21, v[216:219] offset:112
  ds_read_b64_tr_b16 v[80:81], v2 offset:64
  ds_read_b64_tr_b16 v[82:83], v2 offset:208
  ds_read_b64_tr_b16 v[84:85], v2 offset:2368
  ds_read_b64_tr_b16 v[86:87], v2 offset:2512
  ds_read_b64_tr_b16 v[88:89], v2 offset:4672
  ds_read_b64_tr_b16 v[90:91], v2 offset:4816
  ds_read_b64_tr_b16 v[92:93], v2 offset:6976
  ds_read_b64_tr_b16 v[94:95], v2 offset:7120
  v_pk_mul_f32 v[52:53], v[160:161], v[124:125] op_sel:[1,1] op_sel_hi:[1,0] neg_lo:[1,0]
  v_pk_fma_f32 v[130:131], v[160:161], v[124:125], v[52:53] op_sel:[0,0,0] op_sel_hi:[0,1,1]
  v_pk_mul_f32 v[52:53], v[164:165], v[124:125] op_sel:[1,1] op_sel_hi:[1,0] neg_lo:[1,0]
  v_pk_fma_f32 v[132:133], v[164:165], v[124:125], v[52:53] op_sel:[0,0,0] op_sel_hi:[0,1,1]
  v_pk_mul_f32 v[52:53], v[168:169], v[124:125] op_sel:[1,1] op_sel_hi:[1,0] neg_lo:[1,0]
  v_pk_fma_f32 v[134:135], v[168:169], v[124:125], v[52:53] op_sel:[0,0,0] op_sel_hi:[0,1,1]
  v_pk_mul_f32 v[52:53], v[172:173], v[124:125] op_sel:[1,1] op_sel_hi:[1,0] neg_lo:[1,0]
  v_pk_fma_f32 v[136:137], v[172:173], v[124:125], v[52:53] op_sel:[0,0,0] op_sel_hi:[0,1,1]
  v_pk_mul_f32 v[52:53], v[176:177], v[124:125] op_sel:[1,1] op_sel_hi:[1,0] neg_lo:[1,0]
  v_pk_fma_f32 v[138:139], v[176:177], v[124:125], v[52:53] op_sel:[0,0,0] op_sel_hi:[0,1,1]
  v_pk_mul_f32 v[52:53], v[180:181], v[124:125] op_sel:[1,1] op_sel_hi:[1,0] neg_lo:[1,0]
  v_pk_fma_f32 v[140:141], v[180:181], v[124:125], v[52:53] op_sel:[0,0,0] op_sel_hi:[0,1,1]
  v_pk_mul_f32 v[52:53], v[184:185], v[124:125] op_sel:[1,1] op_sel_hi:[1,0] neg_lo:[1,0]
  v_pk_fma_f32 v[142:143], v[184:185], v[124:125], v[52:53] op_sel:[0,0,0] op_sel_hi:[0,1,1]
  s_waitcnt lgkmcnt(6)
  v_mfma_f32_16x16x32_bf16 v[60:63], v[64:67], v[80:83], 0
  s_waitcnt lgkmcnt(4)
  v_mfma_f32_16x16x32_bf16 v[60:63], v[68:71], v[84:87], v[60:63]
  s_waitcnt lgkmcnt(2)
  v_mfma_f32_16x16x32_bf16 v[60:63], v[72:75], v[88:91], v[60:63]
  s_waitcnt lgkmcnt(0)
  v_mfma_f32_16x16x32_bf16 v[60:63], v[76:79], v[92:95], v[60:63]
  v_pk_mul_f32 v[52:53], v[188:189], v[124:125] op_sel:[1,1] op_sel_hi:[1,0] neg_lo:[1,0]
  v_pk_fma_f32 v[144:145], v[188:189], v[124:125], v[52:53] op_sel:[0,0,0] op_sel_hi:[0,1,1]
  v_cvt_pk_bf16_f32 v36, v130, v132
  v_cvt_pk_bf16_f32 v37, v134, v136
  v_cvt_pk_bf16_f32 v38, v138, v140
  v_cvt_pk_bf16_f32 v39, v142, v144
  v_cvt_pk_bf16_f32 v40, -v131, -v133
  ds_write_b128 v21, v[36:39] offset:0
  v_cvt_pk_bf16_f32 v41, -v135, -v137
  v_cvt_pk_bf16_f32 v42, -v139, -v141
  v_cvt_pk_bf16_f32 v43, -v143, -v145
  v_pk_mul_f32 v[52:53], v[124:125], v[124:125] op_sel:[1,1] op_sel_hi:[1,0] neg_lo:[1,0]
  v_pk_fma_f32 v[126:127], v[124:125], v[124:125], v[52:53] op_sel:[0,0,0] op_sel_hi:[0,1,1]
  ds_write_b32 v6, v60 offset:0
  ds_write_b32 v6, v61 offset:144
  ds_write_b32 v6, v62 offset:288
  ds_write_b32 v6, v63 offset:432
  v_pk_mul_f32 v[52:53], v[160:161], v[126:127] op_sel:[1,1] op_sel_hi:[1,0] neg_lo:[1,0]
  v_pk_fma_f32 v[146:147], v[160:161], v[126:127], v[52:53] op_sel:[0,0,0] op_sel_hi:[0,1,1]
  v_pk_mul_f32 v[52:53], v[168:169], v[126:127] op_sel:[1,1] op_sel_hi:[1,0] neg_lo:[1,0]
  v_pk_fma_f32 v[148:149], v[168:169], v[126:127], v[52:53] op_sel:[0,0,0] op_sel_hi:[0,1,1]
  v_pk_mul_f32 v[52:53], v[176:177], v[126:127] op_sel:[1,1] op_sel_hi:[1,0] neg_lo:[1,0]
  ds_write_b128 v21, v[40:43] offset:32
  v_pk_fma_f32 v[150:151], v[176:177], v[126:127], v[52:53] op_sel:[0,0,0] op_sel_hi:[0,1,1]
  v_pk_mul_f32 v[52:53], v[184:185], v[126:127] op_sel:[1,1] op_sel_hi:[1,0] neg_lo:[1,0]
  v_pk_fma_f32 v[152:153], v[184:185], v[126:127], v[52:53] op_sel:[0,0,0] op_sel_hi:[0,1,1]
  v_pk_mul_f32 v[52:53], v[130:131], v[126:127] op_sel:[1,1] op_sel_hi:[1,0] neg_lo:[1,0]
  v_pk_fma_f32 v[154:155], v[130:131], v[126:127], v[52:53] op_sel:[0,0,0] op_sel_hi:[0,1,1]
  v_pk_mul_f32 v[52:53], v[134:135], v[126:127] op_sel:[1,1] op_sel_hi:[1,0] neg_lo:[1,0]
  v_pk_fma_f32 v[156:157], v[134:135], v[126:127], v[52:53] op_sel:[0,0,0] op_sel_hi:[0,1,1]
  v_pk_mul_f32 v[52:53], v[138:139], v[126:127] op_sel:[1,1] op_sel_hi:[1,0] neg_lo:[1,0]
  v_pk_fma_f32 v[158:159], v[138:139], v[126:127], v[52:53] op_sel:[0,0,0] op_sel_hi:[0,1,1]
  v_pk_mul_f32 v[52:53], v[142:143], v[126:127] op_sel:[1,1] op_sel_hi:[1,0] neg_lo:[1,0]
  v_pk_fma_f32 v[192:193], v[142:143], v[126:127], v[52:53] op_sel:[0,0,0] op_sel_hi:[0,1,1]
  v_cvt_pk_bf16_f32 v44, v146, v148
  v_cvt_pk_bf16_f32 v45, v150, v152
  v_cvt_pk_bf16_f32 v46, v154, v156
  v_cvt_pk_bf16_f32 v47, v158, v192
  v_cvt_pk_bf16_f32 v48, -v147, -v149
  ds_write_b128 v21, v[44:47] offset:16
  v_cvt_pk_bf16_f32 v49, -v151, -v153
  v_cvt_pk_bf16_f32 v50, -v155, -v157
  v_cvt_pk_bf16_f32 v51, -v159, -v193
  v_pk_mul_f32 v[52:53], v[126:127], v[126:127] op_sel:[1,1] op_sel_hi:[1,0] neg_lo:[1,0]
  v_pk_fma_f32 v[128:129], v[126:127], v[126:127], v[52:53] op_sel:[0,0,0] op_sel_hi:[0,1,1]
  ds_write_b128 v21, v[48:51] offset:48
  ds_read_b64_tr_b16 v[224:225], v2 offset:0
  ds_read_b64_tr_b16 v[226:227], v2 offset:144
  ds_read_b64_tr_b16 v[228:229], v2 offset:2304
  ds_read_b64_tr_b16 v[230:231], v2 offset:2448
  ds_read_b64_tr_b16 v[232:233], v2 offset:4608
  ds_read_b64_tr_b16 v[234:235], v2 offset:4752
  ds_read_b64_tr_b16 v[236:237], v2 offset:6912
  ds_read_b64_tr_b16 v[238:239], v2 offset:7056
  v_pk_mul_f32 v[52:53], v[160:161], v[128:129] op_sel:[1,1] op_sel_hi:[1,0] neg_lo:[1,0]
  v_pk_fma_f32 v[194:195], v[160:161], v[128:129], v[52:53] op_sel:[0,0,0] op_sel_hi:[0,1,1]
  v_pk_mul_f32 v[52:53], v[176:177], v[128:129] op_sel:[1,1] op_sel_hi:[1,0] neg_lo:[1,0]
  v_pk_fma_f32 v[196:197], v[176:177], v[128:129], v[52:53] op_sel:[0,0,0] op_sel_hi:[0,1,1]
  v_pk_mul_f32 v[52:53], v[130:131], v[128:129] op_sel:[1,1] op_sel_hi:[1,0] neg_lo:[1,0]
  v_pk_fma_f32 v[198:199], v[130:131], v[128:129], v[52:53] op_sel:[0,0,0] op_sel_hi:[0,1,1]
  v_pk_mul_f32 v[52:53], v[138:139], v[128:129] op_sel:[1,1] op_sel_hi:[1,0] neg_lo:[1,0]
  v_pk_fma_f32 v[200:201], v[138:139], v[128:129], v[52:53] op_sel:[0,0,0] op_sel_hi:[0,1,1]
  v_pk_mul_f32 v[52:53], v[146:147], v[128:129] op_sel:[1,1] op_sel_hi:[1,0] neg_lo:[1,0]
  v_pk_fma_f32 v[202:203], v[146:147], v[128:129], v[52:53] op_sel:[0,0,0] op_sel_hi:[0,1,1]
  v_pk_mul_f32 v[52:53], v[150:151], v[128:129] op_sel:[1,1] op_sel_hi:[1,0] neg_lo:[1,0]
  v_pk_fma_f32 v[204:205], v[150:151], v[128:129], v[52:53] op_sel:[0,0,0] op_sel_hi:[0,1,1]
  v_pk_mul_f32 v[52:53], v[154:155], v[128:129] op_sel:[1,1] op_sel_hi:[1,0] neg_lo:[1,0]
  v_pk_fma_f32 v[206:207], v[154:155], v[128:129], v[52:53] op_sel:[0,0,0] op_sel_hi:[0,1,1]
  s_waitcnt lgkmcnt(6)
  v_mfma_f32_16x16x32_bf16 v[56:59], v[64:67], v[224:227], 0
  s_waitcnt lgkmcnt(4)
  v_mfma_f32_16x16x32_bf16 v[56:59], v[68:71], v[228:231], v[56:59]
  s_waitcnt lgkmcnt(2)
  v_mfma_f32_16x16x32_bf16 v[56:59], v[72:75], v[232:235], v[56:59]
  s_waitcnt lgkmcnt(0)
  v_mfma_f32_16x16x32_bf16 v[56:59], v[76:79], v[236:239], v[56:59]
  v_pk_mul_f32 v[52:53], v[158:159], v[128:129] op_sel:[1,1] op_sel_hi:[1,0] neg_lo:[1,0]
  v_pk_fma_f32 v[208:209], v[158:159], v[128:129], v[52:53] op_sel:[0,0,0] op_sel_hi:[0,1,1]
  v_pk_mul_f32 v[52:53], v[194:195], v[128:129] op_sel:[1,1] op_sel_hi:[1,0] neg_lo:[1,0]
  v_pk_fma_f32 v[210:211], v[194:195], v[128:129], v[52:53] op_sel:[0,0,0] op_sel_hi:[0,1,1]
  v_cvt_pk_bf16_f32 v96, v194, v196
  v_cvt_pk_bf16_f32 v97, v198, v200
  v_cvt_pk_bf16_f32 v98, v202, v204
  v_cvt_pk_bf16_f32 v99, v206, v208
  v_cvt_pk_bf16_f32 v100, -v195, -v197
  ds_write_b128 v21, v[96:99] offset:64
  v_cvt_pk_bf16_f32 v101, -v199, -v201
  v_cvt_pk_bf16_f32 v102, -v203, -v205
  v_cvt_pk_bf16_f32 v103, -v207, -v209
  ds_write_b32 v3, v56 offset:4608
  ds_write_b32 v4, v57 offset:4608
  ds_write_b32 v5, v58 offset:4608
  ds_write_b32 v8, v59 offset:4608
  v_cvt_pk_bf16_f32 v212, v210, v210
  v_cvt_pk_bf16_f32 v216, -v211, -v211
  ds_write_b128 v21, v[100:103] offset:96
  ds_write_b32 v21, v212 offset:80
  ds_write_b32 v21, v216 offset:112
  ds_read_b64_tr_b16 v[80:81], v2 offset:64
  ds_read_b64_tr_b16 v[82:83], v2 offset:208
  ds_read_b64_tr_b16 v[84:85], v2 offset:2368
  ds_read_b64_tr_b16 v[86:87], v2 offset:2512
  ds_read_b64_tr_b16 v[88:89], v2 offset:4672
  ds_read_b64_tr_b16 v[90:91], v2 offset:4816
  ds_read_b64_tr_b16 v[92:93], v2 offset:6976
  ds_read_b64_tr_b16 v[94:95], v2 offset:7120
  s_waitcnt lgkmcnt(6)
  v_mfma_f32_16x16x32_bf16 v[240:243], v[64:67], v[80:83], 0
  s_waitcnt lgkmcnt(4)
  v_mfma_f32_16x16x32_bf16 v[240:243], v[68:71], v[84:87], v[240:243]
  s_waitcnt lgkmcnt(2)
  v_mfma_f32_16x16x32_bf16 v[240:243], v[72:75], v[88:91], v[240:243]
  s_waitcnt lgkmcnt(0)
  v_mfma_f32_16x16x32_bf16 v[240:243], v[76:79], v[92:95], v[240:243]
  s_mov_b32 exec_lo, 0x1ff01ff
  s_mov_b32 exec_hi, 0x1ff01ff
  s_nop 5
  ds_write_b32 v7, v240 offset:9216
  ds_write_b32 v7, v241 offset:9232
  ds_write_b32 v7, v242 offset:9248
  ds_write_b32 v7, v243 offset:9264
  s_mov_b64 exec, -1
  s_waitcnt lgkmcnt(0)
  s_barrier
  ds_read_b128 v[64:67], v110
  ds_read_b128 v[68:71], v111
  ds_read_b128 v[72:75], v112
  ds_read_b128 v[76:79], v113
  ds_read_b128 v[80:83], v114
  ds_read_b128 v[84:87], v115
  ds_read_b128 v[88:91], v116
  ds_read_b128 v[92:95], v117
  ds_read_b128 v[96:99], v118
  ds_read_b128 v[100:103], v119
  s_lshl_b32 s70, s75, 10
  s_add_u32 s70, s70, 114688
  v_lshl_add_u32 v16, v1, 4, s70
  s_waitcnt lgkmcnt(9)
  v_add_f32 v24, v64, v65
  v_add_f32 v25, v66, v67
  s_waitcnt lgkmcnt(8)
  v_add_f32 v26, v68, v69
  v_add_f32 v27, v70, v71
  s_waitcnt lgkmcnt(7)
  v_add_f32 v28, v72, v73
  v_add_f32 v29, v74, v75
  s_waitcnt lgkmcnt(6)
  v_add_f32 v30, v76, v77
  v_add_f32 v31, v78, v79
  s_waitcnt lgkmcnt(5)
  v_add_f32 v32, v80, v81
  v_add_f32 v33, v82, v83
  s_waitcnt lgkmcnt(4)
  v_add_f32 v34, v84, v85
  v_add_f32 v35, v86, v87
  s_waitcnt lgkmcnt(3)
  v_add_f32 v36, v88, v89
  v_add_f32 v37, v90, v91
  s_waitcnt lgkmcnt(2)
  v_add_f32 v38, v92, v93
  v_add_f32 v39, v94, v95
  s_waitcnt lgkmcnt(1)
  v_add_f32 v40, v96, v97
  v_add_f32 v41, v98, v99
  s_waitcnt lgkmcnt(0)
  v_add_f32 v42, v100, v101
  v_add_f32 v43, v102, v103
  v_cvt_pk_bf16_f32 v44, v24, v26
  v_cvt_pk_bf16_f32 v45, v28, v30
  v_cvt_pk_bf16_f32 v46, v32, v34
  v_cvt_pk_bf16_f32 v47, v36, v38
  ds_write_b128 v16, v[44:47] offset:0
  v_cvt_pk_bf16_f32 v48, v28, v30
  v_cvt_pk_bf16_f32 v49, v32, v34
  v_cvt_pk_bf16_f32 v50, v36, v38
  v_cvt_pk_bf16_f32 v51, v40, v42
  ds_write_b128 v16, v[48:51] offset:4224
  v_cvt_pk_bf16_f32 v52, v25, v27
  v_cvt_pk_bf16_f32 v53, v29, v31
  v_cvt_pk_bf16_f32 v54, v33, v35
  v_cvt_pk_bf16_f32 v55, v37, v39
  ds_write_b128 v16, v[52:55] offset:17728
  v_cvt_pk_bf16_f32 v56, v29, v31
  v_cvt_pk_bf16_f32 v57, v33, v35
  v_cvt_pk_bf16_f32 v58, v37, v39
  v_cvt_pk_bf16_f32 v59, v41, v43
  ds_write_b128 v16, v[56:59] offset:21952
  v_mov_b32 v60, 0
  v_mov_b32 v61, 0
  v_mov_b32 v62, 0
  v_mov_b32 v63, 0
  s_mul_i32 s70, s77, 4224
  s_add_u32 s70, s70, s80
  v_and_b32 v17, 3, v1
  v_lshl_add_u32 v17, v17, 4, s70
  ds_write_b128 v17, v[60:63] offset:4096
  s_mul_i32 s70, s77, 4640
  s_add_u32 s70, s70, s80
  v_min_u32 v17, 27, v1
  v_lshl_add_u32 v17, v17, 4, s70
  ds_write_b128 v17, v[60:63] offset:8448
  s_waitcnt lgkmcnt(0)
  s_barrier
  v_mov_b32 v12, 163776
  s_cmp_lg_u32 s75, 0
  s_cbranch_scc1 Lw21
  s_mov_b32 s69, 4096
Lp22:
  buffer_load_dword v10, off, s[64:67], 0 offset:128 sc1
  s_waitcnt vmcnt(0)
  v_cmp_eq_u32 vcc, 0, v10
  s_cbranch_vccz Lk23
  s_sub_u32 s69, s69, 1
  s_cbranch_scc0 Lp22
Lk23:
  s_nop 0
  s_nop 0
  ds_write_b32 v12, v10
Lw21:
  s_waitcnt lgkmcnt(0)
  s_mov_b32 s69, 131072
Lp24:
  ds_read_b32 v11, v12
  s_waitcnt lgkmcnt(0)
  v_cmp_eq_u32 vcc, 0, v11
  s_cbranch_vccz Lk25
  s_sub_u32 s69, s69, 1
  s_cbranch_scc0 Lp24
Lk25:
  s_nop 0
  s_nop 0
  v_lshrrev_b32 v16, 3, v1
  v_and_b32 v17, 7, v1
  v_lshlrev_b32 v18, 15, v16
  v_lshl_add_u32 v18, v17, 4, v18
  s_lshl_b32 s70, s75, 19
  s_lshl_b32 s71, s87, 7
  s_add_u32 s70, s70, s71
  v_add_u32 v18, s70, v18
  v_and_b32 v19, 3, v1
  v_cmp_eq_u32 vcc, 0, v19
  v_mov_b32 v20, 4
  v_mov_b32 v21, 32708
  v_cndmask_b32 v20, v20, v21, vcc
  v_sub_u32 v20, v18, v20
  s_mov_b32 s82, 262144
  v_add_u32 v21, s82, v20
  v_min_u32 v20, 0x7fff0000, v20
  buffer_load_dwordx4 v[24:27], v18, s[56:59], 0 offen sc1
  buffer_load_dword v32, v20, s[56:59], 0 offen sc1
  buffer_load_dwordx4 v[28:31], v18, s[56:59], s82 offen sc1
  buffer_load_dword v33, v21, s[56:59], 0 offen sc1
  v_bfe_u32 v17, v1, 2, 1
  v_mul_u32_u24 v17, 17728, v17
  v_lshl_add_u32 v17, v16, 6, v17
  v_lshl_add_u32 v17, v19, 4, v17
  s_lshl_b32 s70, s75, 10
  s_add_u32 s70, s70, 115136
  v_add_u32 v17, s70, v17
  s_waitcnt vmcnt(3)
  ds_write_b128 v17, v[24:27] offset:13088
  s_waitcnt vmcnt(2)
  v_alignbit_b32 v36, v24, v32, 16
  v_alignbit_b32 v37, v25, v24, 16
  v_alignbit_b32 v38, v26, v25, 16
  v_alignbit_b32 v39, v27, v26, 16
  ds_write_b128 v17, v[36:39] offset:8448
  s_waitcnt vmcnt(1)
  ds_write_b128 v17, v[28:31] offset:13600
  s_waitcnt vmcnt(0)
  v_alignbit_b32 v40, v28, v33, 16
  v_alignbit_b32 v41, v29, v28, 16
  v_alignbit_b32 v42, v30, v29, 16
  v_alignbit_b32 v43, v31, v30, 16
  ds_write_b128 v17, v[40:43] offset:8960
  s_lshl_b32 s70, s75, 2
  s_add_u32 s70, s70, 163744
  v_mov_b32 v9, s70
  v_mov_b32 v11, 1
  v_and_b32 v10, 3, v1
  v_lshlrev_b32 v10, 2, v10
  v_add_u32 v10, 163744, v10
  s_waitcnt lgkmcnt(0)
  ds_write_b32 v9, v11
  s_waitcnt lgkmcnt(0)
  s_mov_b32 s69, 131072
Lp26:
  ds_read_b32 v16, v10
  s_waitcnt lgkmcnt(0)
  v_cmp_eq_u32 vcc, 0, v16
  s_cbranch_vccz Lk27
  s_sub_u32 s69, s69, 1
  s_cbranch_scc0 Lp26
Lk27:
  s_nop 0
  s_nop 0
  s_branch LCONV
Lend:
  s_endpgm
.section .rodata,"a"
.p2align 6
.amdhsa_kernel gated_mix__ssm_conv_s4d__glu_gated_reglu__prompt_kernel
  .amdhsa_next_free_vgpr 256
  .amdhsa_next_free_sgpr 102
  .amdhsa_accum_offset 256
  .amdhsa_group_segment_fixed_size 0
  .amdhsa_kernarg_size 120
  .amdhsa_user_sgpr_count 2
  .amdhsa_user_sgpr_kernarg_segment_ptr 1
  .amdhsa_system_sgpr_workgroup_id_x 1
.end_amdhsa_kernel
```
